```python
import torch

def _softmax(x, axis=-1):
    return torch.softmax(x, dim=axis)
def _gelu(x):
    return torch.nn.functional.gelu(x, approximate="tanh")
def _silu(x):
    return torch.nn.functional.silu(x)
def _sigmoid(x):
    return torch.sigmoid(x)
def _layernorm(x, axis=-1, eps=1e-5):
    m = x.mean(dim=axis, keepdim=True)
    v = x.var(dim=axis, keepdim=True, unbiased=False)
    return (x - m) / torch.sqrt(v + eps)
def _scatter_add(tgt, idx, src, axis=0):
    return tgt.clone().index_add_(axis, idx, src)
def _segment_sum(src, seg, n):
    out = torch.zeros((n,) + src.shape[1:], dtype=src.dtype)
    return out.index_add_(0, seg, src)
def _pad(x, pw):
    flat = tuple(v for pair in reversed(pw) for v in pair)
    return torch.nn.functional.pad(x, flat)

kernel_name = 'recurrent_scan__mha_block_cached__glu_gated_geglu__prompt'

def setup_inputs():

    _w = (lambda a: (lambda t: t.to(torch.bfloat16) if t.is_floating_point() else t)(torch.as_tensor(a)))
    def _A_setup():
        B, Sq, D = 1, 2048, 512
        H, Sk, Dh = 32, 2048, 128
        return {
            "x": _w((lambda *s: torch.randn(*s, dtype=torch.bfloat16) * 0.05)(B, Sq, D)),
            "k_cache": _w((lambda *s: torch.randn(*s, dtype=torch.bfloat16) * 3.2)(B, H, Sk, Dh)),
            "v_cache": _w((lambda *s: torch.randn(*s, dtype=torch.bfloat16) * 3.2)(B, H, Sk, Dh)),
            "wq": _w((lambda *s: torch.randn(*s, dtype=torch.bfloat16) * 3.2)(D, H * Dh) * (D ** -0.5)),
            "wo": _w((lambda *s: torch.randn(*s, dtype=torch.bfloat16) * 3.2)(H * Dh, D) * ((H * Dh) ** -0.5)),
        }
    _A_in = _A_setup()

    def _B_setup():
        B, S, Dm, Df = 1, 2048, 512, 1792
        return {
            "x": _w((lambda *s: torch.randn(*s, dtype=torch.bfloat16) * 0.05)(B, S, Dm)),
            "w_gate": _w((lambda *s: torch.randn(*s, dtype=torch.bfloat16) * 0.4)(Dm, Df) * (Dm ** -0.5)),
            "w_up": _w((lambda *s: torch.randn(*s, dtype=torch.bfloat16) * 0.4)(Dm, Df) * (Dm ** -0.5)),
            "w_down": _w((lambda *s: torch.randn(*s, dtype=torch.bfloat16) * 0.4)(Df, Dm) * (Df ** -0.5)),
        }
    _B_in = _B_setup()

    return {
        "A_x": _A_in["x"],
        "A_k_cache": _A_in["k_cache"],
        "A_v_cache": _A_in["v_cache"],
        "A_wq": _A_in["wq"],
        "A_wo": _A_in["wo"],
        "B_x": _B_in["x"],
        "B_w_gate": _B_in["w_gate"],
        "B_w_up": _B_in["w_up"],
        "B_w_down": _B_in["w_down"],
    }

def reference(A_x, A_k_cache, A_v_cache, A_wq, A_wo, B_x, B_w_gate, B_w_up, B_w_down):
    def _A_ref(x, k_cache, v_cache, wq, wo):
        B, Sq, D = x.shape
        H, Dh = 32, 128
        q = (lambda x, *d: x.permute(*d))((x @ wq).reshape(B, Sq, H, Dh), 0, 2, 1, 3)
        scores = torch.einsum("bhqd,bhkd->bhqk", q, k_cache) * (Dh ** -0.5)
        p = _softmax(scores, axis=-1)
        o = torch.einsum("bhqk,bhkd->bhqd", p, v_cache)
        return (lambda x, *d: x.permute(*d))(o, 0, 2, 1, 3).reshape(B, Sq, H * Dh) @ wo

    def _B_ref(x, w_gate, w_up, w_down):
        g = torch.einsum("bsd,df->bsf", x, w_gate)
        u = torch.einsum("bsd,df->bsf", x, w_up)
        h = _gelu(g) * u
        return torch.einsum("bsf,fd->bsd", h, w_down)

    x = A_x
    xn = _layernorm(x, axis=-1)
    s = _A_ref(xn, A_k_cache, A_v_cache, A_wq, A_wo)
    g = _silu(_B_ref(xn, B_w_gate, B_w_up, B_w_down))
    return x + s * g
```

```asm
; @launch kernel=lnorm_kernel grid=(512,1,1) block=(256,1,1) lds=0
; @launch kernel=attn_kernel grid=(256,1,1) block=(512,1,1) lds=163840
; @launch kernel=outp_kernel grid=(256,1,1) block=(512,1,1) lds=131072
.amdgcn_target "amdgcn-amd-amdhsa--gfx950"
.text
.globl lnorm_kernel
.p2align 8
.type lnorm_kernel,@function
lnorm_kernel:
    s_cmp_ge_u32 s2, 512
    s_cbranch_scc1 L_ln_end
    s_load_dwordx2 s[4:5], s[0:1], 0
    s_load_dwordx2 s[6:7], s[0:1], 88
    v_and_b32 v1, 63, v0
    v_lshrrev_b32 v2, 6, v0
    s_lshl_b32 s16, s2, 2
    v_readfirstlane_b32 s18, v2
    s_waitcnt lgkmcnt(0)
    s_mov_b32 s8, s4
    s_and_b32 s9, s5, 0xffff
    s_mov_b32 s10, 0x200000
    s_mov_b32 s11, 0x00020000
    s_mov_b32 s12, s6
    s_and_b32 s13, s7, 0xffff
    s_mov_b32 s14, 0x200000
    s_mov_b32 s15, 0x00020000
    s_add_u32 s16, s16, s18
    s_lshl_b32 s17, s16, 10
    v_lshlrev_b32 v4, 4, v1
    buffer_load_dwordx4 v[12:15], v4, s[8:11], s17 offen
    v_lshrrev_b32 v2, 1, v1
    v_lshlrev_b32 v2, 10, v2
    v_and_b32 v3, 1, v1
    v_lshl_add_u32 v5, v3, 9, v2
    s_lshr_b32 s17, s16, 5
    s_lshl_b32 s17, s17, 15
    s_and_b32 s16, s16, 31
    s_lshl_b32 s16, s16, 4
    s_add_u32 s17, s17, s16
    v_add_u32 v5, s17, v5
    s_waitcnt vmcnt(0)
    v_lshlrev_b32 v16, 16, v12
    v_and_b32 v17, 0xffff0000, v12
    v_lshlrev_b32 v18, 16, v13
    v_and_b32 v19, 0xffff0000, v13
    v_lshlrev_b32 v20, 16, v14
    v_and_b32 v21, 0xffff0000, v14
    v_lshlrev_b32 v22, 16, v15
    v_and_b32 v23, 0xffff0000, v15
    v_add_f32 v6, v16, v17
    v_add_f32 v6, v6, v18
    v_add_f32 v6, v6, v19
    v_add_f32 v6, v6, v20
    v_add_f32 v6, v6, v21
    v_add_f32 v6, v6, v22
    v_add_f32 v6, v6, v23
    ds_swizzle_b32 v2, v6 offset:0x41f
    s_waitcnt lgkmcnt(0)
    v_add_f32 v6, v6, v2
    ds_swizzle_b32 v2, v6 offset:0x81f
    s_waitcnt lgkmcnt(0)
    v_add_f32 v6, v6, v2
    ds_swizzle_b32 v2, v6 offset:0x101f
    s_waitcnt lgkmcnt(0)
    v_add_f32 v6, v6, v2
    ds_swizzle_b32 v2, v6 offset:0x201f
    s_waitcnt lgkmcnt(0)
    v_add_f32 v6, v6, v2
    ds_swizzle_b32 v2, v6 offset:0x401f
    s_waitcnt lgkmcnt(0)
    v_add_f32 v6, v6, v2
    v_mov_b32 v2, v6
    s_nop 1
    v_permlane32_swap_b32 v6, v2
    s_nop 1
    v_add_f32 v6, v6, v2
    v_mul_f32 v7, 0x3b000000, v6
    v_mov_b32 v6, 0
    v_sub_f32 v3, v16, v7
    v_fmac_f32 v6, v3, v3
    v_sub_f32 v3, v17, v7
    v_fmac_f32 v6, v3, v3
    v_sub_f32 v3, v18, v7
    v_fmac_f32 v6, v3, v3
    v_sub_f32 v3, v19, v7
    v_fmac_f32 v6, v3, v3
    v_sub_f32 v3, v20, v7
    v_fmac_f32 v6, v3, v3
    v_sub_f32 v3, v21, v7
    v_fmac_f32 v6, v3, v3
    v_sub_f32 v3, v22, v7
    v_fmac_f32 v6, v3, v3
    v_sub_f32 v3, v23, v7
    v_fmac_f32 v6, v3, v3
    ds_swizzle_b32 v2, v6 offset:0x41f
    s_waitcnt lgkmcnt(0)
    v_add_f32 v6, v6, v2
    ds_swizzle_b32 v2, v6 offset:0x81f
    s_waitcnt lgkmcnt(0)
    v_add_f32 v6, v6, v2
    ds_swizzle_b32 v2, v6 offset:0x101f
    s_waitcnt lgkmcnt(0)
    v_add_f32 v6, v6, v2
    ds_swizzle_b32 v2, v6 offset:0x201f
    s_waitcnt lgkmcnt(0)
    v_add_f32 v6, v6, v2
    ds_swizzle_b32 v2, v6 offset:0x401f
    s_waitcnt lgkmcnt(0)
    v_add_f32 v6, v6, v2
    v_mov_b32 v2, v6
    s_nop 1
    v_permlane32_swap_b32 v6, v2
    s_nop 1
    v_add_f32 v6, v6, v2
    v_mul_f32 v6, 0x3b000000, v6
    v_cvt_pk_bf16_f32 v2, v7, v6
    v_lshlrev_b32 v7, 16, v2
    v_and_b32 v6, 0xffff0000, v2
    v_add_f32 v6, 0x3727c5ac, v6
    v_cvt_pk_bf16_f32 v2, v6, v6
    v_lshlrev_b32 v6, 16, v2
    v_and_b32 v3, 0xffff0000, v2
    v_sqrt_f32 v6, v6
    s_nop 0
    v_cvt_pk_bf16_f32 v2, v6, v6
    v_lshlrev_b32 v6, 16, v2
    v_and_b32 v3, 0xffff0000, v2
    v_rcp_f32 v8, v6
    v_sub_f32 v16, v16, v7
    v_sub_f32 v17, v17, v7
    v_cvt_pk_bf16_f32 v2, v16, v17
    v_lshlrev_b32 v16, 16, v2
    v_and_b32 v17, 0xffff0000, v2
    v_mul_f32 v16, v16, v8
    v_mul_f32 v17, v17, v8
    v_cvt_pk_bf16_f32 v12, v16, v17
    v_sub_f32 v18, v18, v7
    v_sub_f32 v19, v19, v7
    v_cvt_pk_bf16_f32 v2, v18, v19
    v_lshlrev_b32 v18, 16, v2
    v_and_b32 v19, 0xffff0000, v2
    v_mul_f32 v18, v18, v8
    v_mul_f32 v19, v19, v8
    v_cvt_pk_bf16_f32 v13, v18, v19
    v_sub_f32 v20, v20, v7
    v_sub_f32 v21, v21, v7
    v_cvt_pk_bf16_f32 v2, v20, v21
    v_lshlrev_b32 v20, 16, v2
    v_and_b32 v21, 0xffff0000, v2
    v_mul_f32 v20, v20, v8
    v_mul_f32 v21, v21, v8
    v_cvt_pk_bf16_f32 v14, v20, v21
    v_sub_f32 v22, v22, v7
    v_sub_f32 v23, v23, v7
    v_cvt_pk_bf16_f32 v2, v22, v23
    v_lshlrev_b32 v22, 16, v2
    v_and_b32 v23, 0xffff0000, v2
    v_mul_f32 v22, v22, v8
    v_mul_f32 v23, v23, v8
    v_cvt_pk_bf16_f32 v15, v22, v23
    buffer_store_dwordx4 v[12:15], v5, s[12:15], 0 offen
L_ln_end:
    s_endpgm
.globl attn_kernel
.p2align 8
.type attn_kernel,@function
attn_kernel:
    s_cmp_ge_u32 s2, 256
    s_cbranch_scc1 L_attn_end
    s_load_dwordx2 s[4:5], s[0:1], 8
    s_load_dwordx2 s[6:7], s[0:1], 16
    s_load_dwordx2 s[8:9], s[0:1], 24
    s_load_dwordx2 s[10:11], s[0:1], 88
    s_load_dwordx4 s[48:51], s[0:1], 48
    s_load_dwordx2 s[92:93], s[0:1], 32
    s_load_dwordx2 s[94:95], s[0:1], 64
    v_and_b32 v248, 63, v0
    v_lshrrev_b32 v243, 6, v0
    s_lshr_b32 s32, s2, 6
    s_lshl_b32 s32, s32, 3
    s_and_b32 s35, s2, 7
    s_or_b32 s32, s32, s35
    s_bfe_u32 s33, s2, 0x30003
    v_readfirstlane_b32 s34, v243
    s_waitcnt lgkmcnt(0)
    s_lshl_b32 s35, s32, 19
    s_add_u32 s12, s4, s35
    s_addc_u32 s13, s5, 0
    s_and_b32 s13, s13, 0xffff
    s_mov_b32 s14, 0x80000
    s_mov_b32 s15, 0x00020000
    s_add_u32 s16, s6, s35
    s_addc_u32 s17, s7, 0
    s_and_b32 s17, s17, 0xffff
    s_mov_b32 s18, 0x80000
    s_mov_b32 s19, 0x00020000
    s_mov_b32 s20, s8
    s_and_b32 s21, s9, 0xffff
    s_mov_b32 s22, 0x400000
    s_mov_b32 s23, 0x00020000
    s_mov_b32 s24, s10
    s_and_b32 s25, s11, 0xffff
    s_mov_b32 s26, 0x200000
    s_mov_b32 s27, 0x00020000
    s_add_u32 s28, s10, 0x1000000
    s_addc_u32 s29, s11, 0
    s_and_b32 s29, s29, 0xffff
    s_mov_b32 s30, 0x1000000
    s_mov_b32 s31, 0x00020000
    s_mov_b32 s52, s50
    s_and_b32 s53, s51, 0xffff
    s_mov_b32 s54, 0x1c0000
    s_mov_b32 s55, 0x00020000
    s_mov_b32 s48, s48
    s_and_b32 s49, s49, 0xffff
    s_mov_b32 s50, 0x1c0000
    s_mov_b32 s51, 0x00020000
    s_add_u32 s56, s10, 0x200000
    s_addc_u32 s57, s11, 0
    s_and_b32 s57, s57, 0xffff
    s_mov_b32 s58, 0x700000
    s_mov_b32 s59, 0x00020000
    s_cmp_lt_u32 s32, 28
    s_cselect_b32 s58, s58, 0
    v_lshrrev_b32 v243, 4, v248
    v_and_b32 v244, 15, v248
    v_lshlrev_b32 v245, 2, v243
    v_xor_b32 v245, v245, v244
    v_lshlrev_b32 v245, 4, v245
    v_lshl_add_u32 v238, v243, 8, v245
    v_lshl_add_u32 v254, v243, 13, v245
    s_and_b32 s35, s34, 1
    s_lshl_b32 s35, s35, 3
    v_add_u32 v245, s35, v243
    v_xor_b32 v246, v245, v244
    v_lshlrev_b32 v246, 4, v246
    v_lshl_add_u32 v236, v243, 8, v246
    v_add_u32 v245, 4, v245
    v_xor_b32 v246, v245, v244
    v_lshlrev_b32 v246, 4, v246
    v_lshl_add_u32 v237, v243, 8, v246
    s_lshl_b32 s36, s34, 11
    s_add_u32 s42, s36, 98304
    s_add_u32 s43, s36, 0
    v_lshrrev_b32 v243, 3, v248
    s_movk_i32 s35, 3584
    v_mul_lo_u32 v243, v243, s35
    v_lshrrev_b32 v245, 2, v248
    v_and_b32 v245, 4, v245
    v_and_b32 v246, 7, v248
    v_xor_b32 v245, v245, v246
    v_lshl_add_u32 v239, v245, 4, v243
    s_lshl_b32 s44, s33, 3
    s_add_u32 s44, s44, s34
    s_lshl_b32 s45, s44, 15
    v_lshlrev_b32 v249, 4, v248
    s_mul_i32 s84, s34, 57344
    s_lshl_b32 s37, s32, 7
    s_add_u32 s84, s84, s37
    s_lshl_b32 s85, s34, 11
    s_lshl_b32 s86, s34, 17
    s_lshl_b32 s37, s32, 8
    s_add_u32 s86, s86, s37
    s_lshl_b32 s47, s34, 12
    s_lshl_b32 s35, s2, 3
    s_add_u32 s35, s35, s34
    s_lshr_b32 s39, s35, 2
    s_add_u32 s96, s10, 0x2000000
    s_addc_u32 s97, s11, 0
    s_and_b32 s97, s97, 0xffff
    s_mov_b32 s98, 0x5c0000
    s_mov_b32 s99, 0x00020000
    s_cmp_lt_u32 s35, 1472
    s_cselect_b32 s98, s98, 0
    s_cselect_b32 s37, 0x1c0000, 0
    s_cmp_lt_u32 s39, 256
    s_cselect_b32 s92, s92, s94
    s_cselect_b32 s93, s93, s95
    s_cselect_b32 s94, 0x400000, s37
    s_cselect_b32 s37, 0, 256
    s_and_b32 s93, s93, 0xffff
    s_mov_b32 s95, 0x00020000
    s_sub_u32 s37, s39, s37
    s_lshl_b32 s37, s37, 14
    s_and_b32 s35, s35, 3
    s_lshl_b32 s38, s35, 8
    s_add_u32 s37, s37, s38
    s_mov_b32 s100, s37
    s_mul_i32 s35, s35, 1507328
    s_lshl_b32 s39, s39, 10
    s_add_u32 s101, s39, s35
    s_mov_b32 s90, 0x05040100
    s_mov_b32 s91, 0x07060302
    s_add_u32 s37, s84, 0
    s_add_u32 m0, s85, 0
    s_nop 0
    buffer_load_dwordx4 v239, s[48:51], s37 offen lds
    s_add_u32 s37, s84, 0
    s_add_u32 m0, s85, 16384
    s_nop 0
    buffer_load_dwordx4 v239, s[52:55], s37 offen lds
    s_add_u32 s37, s84, 28672
    s_add_u32 m0, s85, 1024
    s_nop 0
    buffer_load_dwordx4 v239, s[48:51], s37 offen lds
    s_add_u32 s37, s84, 28672
    s_add_u32 m0, s85, 17408
    s_nop 0
    buffer_load_dwordx4 v239, s[52:55], s37 offen lds
    s_add_u32 s37, s45, 0
    buffer_load_dwordx4 v[0:3], v249, s[24:27], s37 offen offset:0
    s_add_u32 s37, s45, 0
    buffer_load_dwordx4 v[4:7], v249, s[24:27], s37 offen offset:1024
    s_add_u32 s37, s45, 0
    buffer_load_dwordx4 v[8:11], v249, s[24:27], s37 offen offset:2048
    s_add_u32 s37, s45, 0
    buffer_load_dwordx4 v[12:15], v249, s[24:27], s37 offen offset:3072
    s_add_u32 s37, s45, 4096
    buffer_load_dwordx4 v[16:19], v249, s[24:27], s37 offen offset:0
    s_add_u32 s37, s45, 4096
    buffer_load_dwordx4 v[20:23], v249, s[24:27], s37 offen offset:1024
    s_add_u32 s37, s45, 4096
    buffer_load_dwordx4 v[24:27], v249, s[24:27], s37 offen offset:2048
    s_add_u32 s37, s45, 4096
    buffer_load_dwordx4 v[28:31], v249, s[24:27], s37 offen offset:3072
    s_add_u32 s37, s84, 458752
    s_add_u32 m0, s85, 32768
    s_nop 0
    buffer_load_dwordx4 v239, s[48:51], s37 offen lds
    s_add_u32 s37, s84, 458752
    s_add_u32 m0, s85, 49152
    s_nop 0
    buffer_load_dwordx4 v239, s[52:55], s37 offen lds
    s_add_u32 s37, s84, 487424
    s_add_u32 m0, s85, 33792
    s_nop 0
    buffer_load_dwordx4 v239, s[48:51], s37 offen lds
    s_add_u32 s37, s84, 487424
    s_add_u32 m0, s85, 50176
    s_nop 0
    buffer_load_dwordx4 v239, s[52:55], s37 offen lds
    s_add_u32 s37, s45, 8192
    buffer_load_dwordx4 v[32:35], v249, s[24:27], s37 offen offset:0
    s_add_u32 s37, s45, 8192
    buffer_load_dwordx4 v[36:39], v249, s[24:27], s37 offen offset:1024
    s_add_u32 s37, s45, 8192
    buffer_load_dwordx4 v[40:43], v249, s[24:27], s37 offen offset:2048
    s_add_u32 s37, s45, 8192
    buffer_load_dwordx4 v[44:47], v249, s[24:27], s37 offen offset:3072
    s_add_u32 s37, s45, 12288
    buffer_load_dwordx4 v[48:51], v249, s[24:27], s37 offen offset:0
    s_add_u32 s37, s45, 12288
    buffer_load_dwordx4 v[52:55], v249, s[24:27], s37 offen offset:1024
    s_add_u32 s37, s45, 12288
    buffer_load_dwordx4 v[56:59], v249, s[24:27], s37 offen offset:2048
    s_add_u32 s37, s45, 12288
    buffer_load_dwordx4 v[60:63], v249, s[24:27], s37 offen offset:3072
    s_add_u32 s40, s36, 32768
    s_add_u32 s41, s36, 32768
    s_lshl_b32 s46, s44, 18
    s_lshl_b32 s37, s32, 13
    s_add_u32 s46, s46, s37
    s_mul_i32 s87, s44, 114688
    s_lshl_b32 s37, s32, 12
    s_add_u32 s87, s87, s37
    v_and_b32 v245, 16, v248
    v_lshlrev_b32 v245, 1, v245
    v_and_b32 v243, 1, v248
    v_lshlrev_b32 v243, 4, v243
    v_and_b32 v244, 2, v248
    v_lshlrev_b32 v244, 2, v244
    v_add3_u32 v245, v245, v243, v244
    v_bfe_u32 v244, v248, 2, 2
    v_lshrrev_b32 v243, 5, v248
    v_lshl_add_u32 v246, v243, 3, v244
    v_lshl_add_u32 v247, v246, 7, v245
    v_lshrrev_b32 v227, 1, v244
    v_lshlrev_b32 v227, 6, v227
    v_add_u32 v224, v247, v227
    v_xor_b32 v227, 64, v227
    v_add_u32 v225, v247, v227
    v_add_u32 v226, 0x4000, v224
    v_add_u32 v227, 0x4000, v225
    v_lshl_add_u32 v246, v246, 8, v245
    v_lshl_add_u32 v247, v243, 2, v244
    v_lshl_add_u32 v247, v247, 8, v245
    v_xor_b32 v245, 0, v244
    v_lshlrev_b32 v245, 6, v245
    v_add_u32 v250, v246, v245
    v_add_u32 v232, v247, v245
    v_xor_b32 v245, 1, v244
    v_lshlrev_b32 v245, 6, v245
    v_add_u32 v251, v246, v245
    v_add_u32 v233, v247, v245
    v_xor_b32 v245, 2, v244
    v_lshlrev_b32 v245, 6, v245
    v_add_u32 v252, v246, v245
    v_add_u32 v234, v247, v245
    v_xor_b32 v245, 3, v244
    v_lshlrev_b32 v245, 6, v245
    v_add_u32 v253, v246, v245
    v_add_u32 v235, v247, v245
    s_mov_b32 s38, 0x3e0293ee
    s_waitcnt vmcnt(12)
    s_barrier
    ds_read_b64_tr_b16 v[128:129], v224 offset:0
    ds_read_b64_tr_b16 v[130:131], v224 offset:512
    ds_read_b64_tr_b16 v[132:133], v225 offset:0
    ds_read_b64_tr_b16 v[134:135], v225 offset:512
    ds_read_b64_tr_b16 v[136:137], v226 offset:0
    ds_read_b64_tr_b16 v[138:139], v226 offset:512
    ds_read_b64_tr_b16 v[140:141], v227 offset:0
    ds_read_b64_tr_b16 v[142:143], v227 offset:512
    ds_read_b64_tr_b16 v[144:145], v224 offset:2048
    ds_read_b64_tr_b16 v[146:147], v224 offset:2560
    ds_read_b64_tr_b16 v[148:149], v225 offset:2048
    ds_read_b64_tr_b16 v[150:151], v225 offset:2560
    s_waitcnt lgkmcnt(10)
    v_mfma_f32_32x32x16_bf16 v[160:175], v[128:131], v[0:3], 0
    s_add_u32 s37, s84, 917504
    s_add_u32 m0, s85, 65536
    s_nop 0
    buffer_load_dwordx4 v239, s[48:51], s37 offen lds
    ds_read_b64_tr_b16 v[152:153], v226 offset:2048
    ds_read_b64_tr_b16 v[154:155], v226 offset:2560
    s_waitcnt lgkmcnt(10)
    v_mfma_f32_32x32x16_bf16 v[176:191], v[132:135], v[0:3], 0
    ds_read_b64_tr_b16 v[156:157], v227 offset:2048
    ds_read_b64_tr_b16 v[158:159], v227 offset:2560
    s_waitcnt lgkmcnt(10)
    v_mfma_f32_32x32x16_bf16 v[192:207], v[136:139], v[0:3], 0
    s_add_u32 s37, s84, 917504
    s_add_u32 m0, s85, 81920
    s_nop 0
    buffer_load_dwordx4 v239, s[52:55], s37 offen lds
    ds_read_b64_tr_b16 v[128:129], v224 offset:4096
    ds_read_b64_tr_b16 v[130:131], v224 offset:4608
    s_waitcnt lgkmcnt(10)
    v_mfma_f32_32x32x16_bf16 v[208:223], v[140:143], v[0:3], 0
    ds_read_b64_tr_b16 v[132:133], v225 offset:4096
    ds_read_b64_tr_b16 v[134:135], v225 offset:4608
    s_waitcnt lgkmcnt(10)
    v_mfma_f32_32x32x16_bf16 v[160:175], v[144:147], v[4:7], v[160:175]
    s_add_u32 s37, s84, 946176
    s_add_u32 m0, s85, 66560
    s_nop 0
    buffer_load_dwordx4 v239, s[48:51], s37 offen lds
    ds_read_b64_tr_b16 v[136:137], v226 offset:4096
    ds_read_b64_tr_b16 v[138:139], v226 offset:4608
    s_waitcnt lgkmcnt(10)
    v_mfma_f32_32x32x16_bf16 v[176:191], v[148:151], v[4:7], v[176:191]
    ds_read_b64_tr_b16 v[140:141], v227 offset:4096
    ds_read_b64_tr_b16 v[142:143], v227 offset:4608
    s_waitcnt lgkmcnt(10)
    v_mfma_f32_32x32x16_bf16 v[192:207], v[152:155], v[4:7], v[192:207]
    s_add_u32 s37, s84, 946176
    s_add_u32 m0, s85, 82944
    s_nop 0
    buffer_load_dwordx4 v239, s[52:55], s37 offen lds
    ds_read_b64_tr_b16 v[144:145], v224 offset:6144
    ds_read_b64_tr_b16 v[146:147], v224 offset:6656
    s_waitcnt lgkmcnt(10)
    v_mfma_f32_32x32x16_bf16 v[208:223], v[156:159], v[4:7], v[208:223]
    ds_read_b64_tr_b16 v[148:149], v225 offset:6144
    ds_read_b64_tr_b16 v[150:151], v225 offset:6656
    s_waitcnt lgkmcnt(10)
    v_mfma_f32_32x32x16_bf16 v[160:175], v[128:131], v[8:11], v[160:175]
    s_add_u32 s37, s45, 16384
    buffer_load_dwordx4 v[64:67], v249, s[24:27], s37 offen offset:0
    ds_read_b64_tr_b16 v[152:153], v226 offset:6144
    ds_read_b64_tr_b16 v[154:155], v226 offset:6656
    s_waitcnt lgkmcnt(10)
    v_mfma_f32_32x32x16_bf16 v[176:191], v[132:135], v[8:11], v[176:191]
    ds_read_b64_tr_b16 v[156:157], v227 offset:6144
    ds_read_b64_tr_b16 v[158:159], v227 offset:6656
    s_waitcnt lgkmcnt(10)
    v_mfma_f32_32x32x16_bf16 v[192:207], v[136:139], v[8:11], v[192:207]
    s_add_u32 s37, s45, 16384
    buffer_load_dwordx4 v[68:71], v249, s[24:27], s37 offen offset:1024
    ds_read_b64_tr_b16 v[128:129], v224 offset:8192
    ds_read_b64_tr_b16 v[130:131], v224 offset:8704
    s_waitcnt lgkmcnt(10)
    v_mfma_f32_32x32x16_bf16 v[208:223], v[140:143], v[8:11], v[208:223]
    ds_read_b64_tr_b16 v[132:133], v225 offset:8192
    ds_read_b64_tr_b16 v[134:135], v225 offset:8704
    s_waitcnt lgkmcnt(10)
    v_mfma_f32_32x32x16_bf16 v[160:175], v[144:147], v[12:15], v[160:175]
    s_add_u32 s37, s45, 16384
    buffer_load_dwordx4 v[72:75], v249, s[24:27], s37 offen offset:2048
    ds_read_b64_tr_b16 v[136:137], v226 offset:8192
    ds_read_b64_tr_b16 v[138:139], v226 offset:8704
    s_waitcnt lgkmcnt(10)
    v_mfma_f32_32x32x16_bf16 v[176:191], v[148:151], v[12:15], v[176:191]
    ds_read_b64_tr_b16 v[140:141], v227 offset:8192
    ds_read_b64_tr_b16 v[142:143], v227 offset:8704
    s_waitcnt lgkmcnt(10)
    v_mfma_f32_32x32x16_bf16 v[192:207], v[152:155], v[12:15], v[192:207]
    s_add_u32 s37, s45, 16384
    buffer_load_dwordx4 v[76:79], v249, s[24:27], s37 offen offset:3072
    ds_read_b64_tr_b16 v[144:145], v224 offset:10240
    ds_read_b64_tr_b16 v[146:147], v224 offset:10752
    s_waitcnt lgkmcnt(10)
    v_mfma_f32_32x32x16_bf16 v[208:223], v[156:159], v[12:15], v[208:223]
    ds_read_b64_tr_b16 v[148:149], v225 offset:10240
    ds_read_b64_tr_b16 v[150:151], v225 offset:10752
    s_waitcnt lgkmcnt(10)
    v_mfma_f32_32x32x16_bf16 v[160:175], v[128:131], v[16:19], v[160:175]
    s_add_u32 s37, s45, 20480
    buffer_load_dwordx4 v[80:83], v249, s[24:27], s37 offen offset:0
    ds_read_b64_tr_b16 v[152:153], v226 offset:10240
    ds_read_b64_tr_b16 v[154:155], v226 offset:10752
    s_waitcnt lgkmcnt(10)
    v_mfma_f32_32x32x16_bf16 v[176:191], v[132:135], v[16:19], v[176:191]
    ds_read_b64_tr_b16 v[156:157], v227 offset:10240
    ds_read_b64_tr_b16 v[158:159], v227 offset:10752
    s_waitcnt lgkmcnt(10)
    v_mfma_f32_32x32x16_bf16 v[192:207], v[136:139], v[16:19], v[192:207]
    s_add_u32 s37, s45, 20480
    buffer_load_dwordx4 v[84:87], v249, s[24:27], s37 offen offset:1024
    ds_read_b64_tr_b16 v[128:129], v224 offset:12288
    ds_read_b64_tr_b16 v[130:131], v224 offset:12800
    s_waitcnt lgkmcnt(10)
    v_mfma_f32_32x32x16_bf16 v[208:223], v[140:143], v[16:19], v[208:223]
    ds_read_b64_tr_b16 v[132:133], v225 offset:12288
    ds_read_b64_tr_b16 v[134:135], v225 offset:12800
    s_waitcnt lgkmcnt(10)
    v_mfma_f32_32x32x16_bf16 v[160:175], v[144:147], v[20:23], v[160:175]
    s_add_u32 s37, s45, 20480
    buffer_load_dwordx4 v[88:91], v249, s[24:27], s37 offen offset:2048
    ds_read_b64_tr_b16 v[136:137], v226 offset:12288
    ds_read_b64_tr_b16 v[138:139], v226 offset:12800
    s_waitcnt lgkmcnt(10)
    v_mfma_f32_32x32x16_bf16 v[176:191], v[148:151], v[20:23], v[176:191]
    ds_read_b64_tr_b16 v[140:141], v227 offset:12288
    ds_read_b64_tr_b16 v[142:143], v227 offset:12800
    s_waitcnt lgkmcnt(10)
    v_mfma_f32_32x32x16_bf16 v[192:207], v[152:155], v[20:23], v[192:207]
    s_add_u32 s37, s45, 20480
    buffer_load_dwordx4 v[92:95], v249, s[24:27], s37 offen offset:3072
    ds_read_b64_tr_b16 v[144:145], v224 offset:14336
    ds_read_b64_tr_b16 v[146:147], v224 offset:14848
    s_waitcnt lgkmcnt(10)
    v_mfma_f32_32x32x16_bf16 v[208:223], v[156:159], v[20:23], v[208:223]
    ds_read_b64_tr_b16 v[148:149], v225 offset:14336
    ds_read_b64_tr_b16 v[150:151], v225 offset:14848
    s_waitcnt lgkmcnt(10)
    v_mfma_f32_32x32x16_bf16 v[160:175], v[128:131], v[24:27], v[160:175]
    ds_read_b64_tr_b16 v[152:153], v226 offset:14336
    ds_read_b64_tr_b16 v[154:155], v226 offset:14848
    s_waitcnt lgkmcnt(10)
    v_mfma_f32_32x32x16_bf16 v[176:191], v[132:135], v[24:27], v[176:191]
    ds_read_b64_tr_b16 v[156:157], v227 offset:14336
    ds_read_b64_tr_b16 v[158:159], v227 offset:14848
    s_waitcnt lgkmcnt(10)
    v_mfma_f32_32x32x16_bf16 v[192:207], v[136:139], v[24:27], v[192:207]
    s_waitcnt lgkmcnt(8)
    v_mfma_f32_32x32x16_bf16 v[208:223], v[140:143], v[24:27], v[208:223]
    s_waitcnt lgkmcnt(6)
    v_mfma_f32_32x32x16_bf16 v[160:175], v[144:147], v[28:31], v[160:175]
    s_waitcnt lgkmcnt(4)
    v_mfma_f32_32x32x16_bf16 v[176:191], v[148:151], v[28:31], v[176:191]
    s_waitcnt lgkmcnt(2)
    v_mfma_f32_32x32x16_bf16 v[192:207], v[152:155], v[28:31], v[192:207]
    s_waitcnt lgkmcnt(0)
    v_mfma_f32_32x32x16_bf16 v[208:223], v[156:159], v[28:31], v[208:223]
    s_waitcnt vmcnt(12)
    s_barrier
    ds_read_b64_tr_b16 v[128:129], v224 offset:32768
    ds_read_b64_tr_b16 v[130:131], v224 offset:33280
    ds_read_b64_tr_b16 v[132:133], v225 offset:32768
    ds_read_b64_tr_b16 v[134:135], v225 offset:33280
    ds_read_b64_tr_b16 v[136:137], v226 offset:32768
    ds_read_b64_tr_b16 v[138:139], v226 offset:33280
    ds_read_b64_tr_b16 v[140:141], v227 offset:32768
    ds_read_b64_tr_b16 v[142:143], v227 offset:33280
    ds_read_b64_tr_b16 v[144:145], v224 offset:34816
    ds_read_b64_tr_b16 v[146:147], v224 offset:35328
    ds_read_b64_tr_b16 v[148:149], v225 offset:34816
    ds_read_b64_tr_b16 v[150:151], v225 offset:35328
    s_waitcnt lgkmcnt(10)
    v_mfma_f32_32x32x16_bf16 v[160:175], v[128:131], v[32:35], v[160:175]
    s_add_u32 s37, s84, 1376256
    s_add_u32 m0, s85, 98304
    s_nop 0
    buffer_load_dwordx4 v239, s[48:51], s37 offen lds
    ds_read_b64_tr_b16 v[152:153], v226 offset:34816
    ds_read_b64_tr_b16 v[154:155], v226 offset:35328
    s_waitcnt lgkmcnt(10)
    v_mfma_f32_32x32x16_bf16 v[176:191], v[132:135], v[32:35], v[176:191]
    ds_read_b64_tr_b16 v[156:157], v227 offset:34816
    ds_read_b64_tr_b16 v[158:159], v227 offset:35328
    s_waitcnt lgkmcnt(10)
    v_mfma_f32_32x32x16_bf16 v[192:207], v[136:139], v[32:35], v[192:207]
    s_add_u32 s37, s84, 1376256
    s_add_u32 m0, s85, 114688
    s_nop 0
    buffer_load_dwordx4 v239, s[52:55], s37 offen lds
    ds_read_b64_tr_b16 v[128:129], v224 offset:36864
    ds_read_b64_tr_b16 v[130:131], v224 offset:37376
    s_waitcnt lgkmcnt(10)
    v_mfma_f32_32x32x16_bf16 v[208:223], v[140:143], v[32:35], v[208:223]
    ds_read_b64_tr_b16 v[132:133], v225 offset:36864
    ds_read_b64_tr_b16 v[134:135], v225 offset:37376
    s_waitcnt lgkmcnt(10)
    v_mfma_f32_32x32x16_bf16 v[160:175], v[144:147], v[36:39], v[160:175]
    s_add_u32 s37, s84, 1404928
    s_add_u32 m0, s85, 99328
    s_nop 0
    buffer_load_dwordx4 v239, s[48:51], s37 offen lds
    ds_read_b64_tr_b16 v[136:137], v226 offset:36864
    ds_read_b64_tr_b16 v[138:139], v226 offset:37376
    s_waitcnt lgkmcnt(10)
    v_mfma_f32_32x32x16_bf16 v[176:191], v[148:151], v[36:39], v[176:191]
    ds_read_b64_tr_b16 v[140:141], v227 offset:36864
    ds_read_b64_tr_b16 v[142:143], v227 offset:37376
    s_waitcnt lgkmcnt(10)
    v_mfma_f32_32x32x16_bf16 v[192:207], v[152:155], v[36:39], v[192:207]
    s_add_u32 s37, s84, 1404928
    s_add_u32 m0, s85, 115712
    s_nop 0
    buffer_load_dwordx4 v239, s[52:55], s37 offen lds
    ds_read_b64_tr_b16 v[144:145], v224 offset:38912
    ds_read_b64_tr_b16 v[146:147], v224 offset:39424
    s_waitcnt lgkmcnt(10)
    v_mfma_f32_32x32x16_bf16 v[208:223], v[156:159], v[36:39], v[208:223]
    ds_read_b64_tr_b16 v[148:149], v225 offset:38912
    ds_read_b64_tr_b16 v[150:151], v225 offset:39424
    s_waitcnt lgkmcnt(10)
    v_mfma_f32_32x32x16_bf16 v[160:175], v[128:131], v[40:43], v[160:175]
    s_add_u32 s37, s45, 24576
    buffer_load_dwordx4 v[96:99], v249, s[24:27], s37 offen offset:0
    ds_read_b64_tr_b16 v[152:153], v226 offset:38912
    ds_read_b64_tr_b16 v[154:155], v226 offset:39424
    s_waitcnt lgkmcnt(10)
    v_mfma_f32_32x32x16_bf16 v[176:191], v[132:135], v[40:43], v[176:191]
    ds_read_b64_tr_b16 v[156:157], v227 offset:38912
    ds_read_b64_tr_b16 v[158:159], v227 offset:39424
    s_waitcnt lgkmcnt(10)
    v_mfma_f32_32x32x16_bf16 v[192:207], v[136:139], v[40:43], v[192:207]
    s_add_u32 s37, s45, 24576
    buffer_load_dwordx4 v[100:103], v249, s[24:27], s37 offen offset:1024
    ds_read_b64_tr_b16 v[128:129], v224 offset:40960
    ds_read_b64_tr_b16 v[130:131], v224 offset:41472
    s_waitcnt lgkmcnt(10)
    v_mfma_f32_32x32x16_bf16 v[208:223], v[140:143], v[40:43], v[208:223]
    ds_read_b64_tr_b16 v[132:133], v225 offset:40960
    ds_read_b64_tr_b16 v[134:135], v225 offset:41472
    s_waitcnt lgkmcnt(10)
    v_mfma_f32_32x32x16_bf16 v[160:175], v[144:147], v[44:47], v[160:175]
    s_add_u32 s37, s45, 24576
    buffer_load_dwordx4 v[104:107], v249, s[24:27], s37 offen offset:2048
    ds_read_b64_tr_b16 v[136:137], v226 offset:40960
    ds_read_b64_tr_b16 v[138:139], v226 offset:41472
    s_waitcnt lgkmcnt(10)
    v_mfma_f32_32x32x16_bf16 v[176:191], v[148:151], v[44:47], v[176:191]
    ds_read_b64_tr_b16 v[140:141], v227 offset:40960
    ds_read_b64_tr_b16 v[142:143], v227 offset:41472
    s_waitcnt lgkmcnt(10)
    v_mfma_f32_32x32x16_bf16 v[192:207], v[152:155], v[44:47], v[192:207]
    s_add_u32 s37, s45, 24576
    buffer_load_dwordx4 v[108:111], v249, s[24:27], s37 offen offset:3072
    ds_read_b64_tr_b16 v[144:145], v224 offset:43008
    ds_read_b64_tr_b16 v[146:147], v224 offset:43520
    s_waitcnt lgkmcnt(10)
    v_mfma_f32_32x32x16_bf16 v[208:223], v[156:159], v[44:47], v[208:223]
    ds_read_b64_tr_b16 v[148:149], v225 offset:43008
    ds_read_b64_tr_b16 v[150:151], v225 offset:43520
    s_waitcnt lgkmcnt(10)
    v_mfma_f32_32x32x16_bf16 v[160:175], v[128:131], v[48:51], v[160:175]
    s_add_u32 s37, s45, 28672
    buffer_load_dwordx4 v[112:115], v249, s[24:27], s37 offen offset:0
    ds_read_b64_tr_b16 v[152:153], v226 offset:43008
    ds_read_b64_tr_b16 v[154:155], v226 offset:43520
    s_waitcnt lgkmcnt(10)
    v_mfma_f32_32x32x16_bf16 v[176:191], v[132:135], v[48:51], v[176:191]
    ds_read_b64_tr_b16 v[156:157], v227 offset:43008
    ds_read_b64_tr_b16 v[158:159], v227 offset:43520
    s_waitcnt lgkmcnt(10)
    v_mfma_f32_32x32x16_bf16 v[192:207], v[136:139], v[48:51], v[192:207]
    s_add_u32 s37, s45, 28672
    buffer_load_dwordx4 v[116:119], v249, s[24:27], s37 offen offset:1024
    ds_read_b64_tr_b16 v[128:129], v224 offset:45056
    ds_read_b64_tr_b16 v[130:131], v224 offset:45568
    s_waitcnt lgkmcnt(10)
    v_mfma_f32_32x32x16_bf16 v[208:223], v[140:143], v[48:51], v[208:223]
    ds_read_b64_tr_b16 v[132:133], v225 offset:45056
    ds_read_b64_tr_b16 v[134:135], v225 offset:45568
    s_waitcnt lgkmcnt(10)
    v_mfma_f32_32x32x16_bf16 v[160:175], v[144:147], v[52:55], v[160:175]
    s_add_u32 s37, s45, 28672
    buffer_load_dwordx4 v[120:123], v249, s[24:27], s37 offen offset:2048
    ds_read_b64_tr_b16 v[136:137], v226 offset:45056
    ds_read_b64_tr_b16 v[138:139], v226 offset:45568
    s_waitcnt lgkmcnt(10)
    v_mfma_f32_32x32x16_bf16 v[176:191], v[148:151], v[52:55], v[176:191]
    ds_read_b64_tr_b16 v[140:141], v227 offset:45056
    ds_read_b64_tr_b16 v[142:143], v227 offset:45568
    s_waitcnt lgkmcnt(10)
    v_mfma_f32_32x32x16_bf16 v[192:207], v[152:155], v[52:55], v[192:207]
    s_add_u32 s37, s45, 28672
    buffer_load_dwordx4 v[124:127], v249, s[24:27], s37 offen offset:3072
    ds_read_b64_tr_b16 v[144:145], v224 offset:47104
    ds_read_b64_tr_b16 v[146:147], v224 offset:47616
    s_waitcnt lgkmcnt(10)
    v_mfma_f32_32x32x16_bf16 v[208:223], v[156:159], v[52:55], v[208:223]
    ds_read_b64_tr_b16 v[148:149], v225 offset:47104
    ds_read_b64_tr_b16 v[150:151], v225 offset:47616
    s_waitcnt lgkmcnt(10)
    v_mfma_f32_32x32x16_bf16 v[160:175], v[128:131], v[56:59], v[160:175]
    s_add_u32 s37, s86, 0
    s_add_u32 m0, s47, 0
    s_nop 0
    buffer_load_dwordx4 v254, s[20:23], s37 offen lds
    ds_read_b64_tr_b16 v[152:153], v226 offset:47104
    ds_read_b64_tr_b16 v[154:155], v226 offset:47616
    s_waitcnt lgkmcnt(10)
    v_mfma_f32_32x32x16_bf16 v[176:191], v[132:135], v[56:59], v[176:191]
    ds_read_b64_tr_b16 v[156:157], v227 offset:47104
    ds_read_b64_tr_b16 v[158:159], v227 offset:47616
    s_waitcnt lgkmcnt(10)
    v_mfma_f32_32x32x16_bf16 v[192:207], v[136:139], v[56:59], v[192:207]
    s_add_u32 s37, s86, 32768
    s_add_u32 m0, s47, 1024
    s_nop 0
    buffer_load_dwordx4 v254, s[20:23], s37 offen lds
    s_waitcnt lgkmcnt(8)
    v_mfma_f32_32x32x16_bf16 v[208:223], v[140:143], v[56:59], v[208:223]
    s_waitcnt lgkmcnt(6)
    v_mfma_f32_32x32x16_bf16 v[160:175], v[144:147], v[60:63], v[160:175]
    s_add_u32 s37, s86, 65536
    s_add_u32 m0, s47, 2048
    s_nop 0
    buffer_load_dwordx4 v254, s[20:23], s37 offen lds
    s_waitcnt lgkmcnt(4)
    v_mfma_f32_32x32x16_bf16 v[176:191], v[148:151], v[60:63], v[176:191]
    s_waitcnt lgkmcnt(2)
    v_mfma_f32_32x32x16_bf16 v[192:207], v[152:155], v[60:63], v[192:207]
    s_add_u32 s37, s86, 98304
    s_add_u32 m0, s47, 3072
    s_nop 0
    buffer_load_dwordx4 v254, s[20:23], s37 offen lds
    s_waitcnt lgkmcnt(0)
    v_mfma_f32_32x32x16_bf16 v[208:223], v[156:159], v[60:63], v[208:223]
    s_waitcnt vmcnt(16)
    s_barrier
    v_add_u32 v224, 0x10000, v224
    v_add_u32 v225, 0x10000, v225
    v_add_u32 v226, 0x10000, v226
    v_add_u32 v227, 0x10000, v227
    ds_read_b64_tr_b16 v[128:129], v224 offset:0
    ds_read_b64_tr_b16 v[130:131], v224 offset:512
    ds_read_b64_tr_b16 v[132:133], v225 offset:0
    ds_read_b64_tr_b16 v[134:135], v225 offset:512
    ds_read_b64_tr_b16 v[136:137], v226 offset:0
    ds_read_b64_tr_b16 v[138:139], v226 offset:512
    ds_read_b64_tr_b16 v[140:141], v227 offset:0
    ds_read_b64_tr_b16 v[142:143], v227 offset:512
    ds_read_b64_tr_b16 v[144:145], v224 offset:2048
    ds_read_b64_tr_b16 v[146:147], v224 offset:2560
    ds_read_b64_tr_b16 v[148:149], v225 offset:2048
    ds_read_b64_tr_b16 v[150:151], v225 offset:2560
    s_waitcnt lgkmcnt(10)
    v_mfma_f32_32x32x16_bf16 v[160:175], v[128:131], v[64:67], v[160:175]
    s_add_u32 s37, s86, 1048576
    s_add_u32 m0, s47, 32768
    s_nop 0
    buffer_load_dwordx4 v254, s[20:23], s37 offen lds
    ds_read_b64_tr_b16 v[152:153], v226 offset:2048
    ds_read_b64_tr_b16 v[154:155], v226 offset:2560
    s_waitcnt lgkmcnt(10)
    v_mfma_f32_32x32x16_bf16 v[176:191], v[132:135], v[64:67], v[176:191]
    ds_read_b64_tr_b16 v[156:157], v227 offset:2048
    ds_read_b64_tr_b16 v[158:159], v227 offset:2560
    s_waitcnt lgkmcnt(10)
    v_mfma_f32_32x32x16_bf16 v[192:207], v[136:139], v[64:67], v[192:207]
    s_add_u32 s37, s86, 1081344
    s_add_u32 m0, s47, 33792
    s_nop 0
    buffer_load_dwordx4 v254, s[20:23], s37 offen lds
    ds_read_b64_tr_b16 v[128:129], v224 offset:4096
    ds_read_b64_tr_b16 v[130:131], v224 offset:4608
    s_waitcnt lgkmcnt(10)
    v_mfma_f32_32x32x16_bf16 v[208:223], v[140:143], v[64:67], v[208:223]
    ds_read_b64_tr_b16 v[132:133], v225 offset:4096
    ds_read_b64_tr_b16 v[134:135], v225 offset:4608
    s_waitcnt lgkmcnt(10)
    v_mfma_f32_32x32x16_bf16 v[160:175], v[144:147], v[68:71], v[160:175]
    s_add_u32 s37, s86, 1114112
    s_add_u32 m0, s47, 34816
    s_nop 0
    buffer_load_dwordx4 v254, s[20:23], s37 offen lds
    ds_read_b64_tr_b16 v[136:137], v226 offset:4096
    ds_read_b64_tr_b16 v[138:139], v226 offset:4608
    s_waitcnt lgkmcnt(10)
    v_mfma_f32_32x32x16_bf16 v[176:191], v[148:151], v[68:71], v[176:191]
    ds_read_b64_tr_b16 v[140:141], v227 offset:4096
    ds_read_b64_tr_b16 v[142:143], v227 offset:4608
    s_waitcnt lgkmcnt(10)
    v_mfma_f32_32x32x16_bf16 v[192:207], v[152:155], v[68:71], v[192:207]
    s_add_u32 s37, s86, 1146880
    s_add_u32 m0, s47, 35840
    s_nop 0
    buffer_load_dwordx4 v254, s[20:23], s37 offen lds
    ds_read_b64_tr_b16 v[144:145], v224 offset:6144
    ds_read_b64_tr_b16 v[146:147], v224 offset:6656
    s_waitcnt lgkmcnt(10)
    v_mfma_f32_32x32x16_bf16 v[208:223], v[156:159], v[68:71], v[208:223]
    ds_read_b64_tr_b16 v[148:149], v225 offset:6144
    ds_read_b64_tr_b16 v[150:151], v225 offset:6656
    s_waitcnt lgkmcnt(10)
    v_mfma_f32_32x32x16_bf16 v[160:175], v[128:131], v[72:75], v[160:175]
    s_add_u32 s37, s36, 0
    s_add_u32 m0, s42, 32768
    s_nop 0
    buffer_load_dwordx4 v236, s[12:15], s37 offen lds
    ds_read_b64_tr_b16 v[152:153], v226 offset:6144
    ds_read_b64_tr_b16 v[154:155], v226 offset:6656
    s_waitcnt lgkmcnt(10)
    v_mfma_f32_32x32x16_bf16 v[176:191], v[132:135], v[72:75], v[176:191]
    ds_read_b64_tr_b16 v[156:157], v227 offset:6144
    ds_read_b64_tr_b16 v[158:159], v227 offset:6656
    s_waitcnt lgkmcnt(10)
    v_mfma_f32_32x32x16_bf16 v[192:207], v[136:139], v[72:75], v[192:207]
    buffer_load_dwordx4 v237, s[12:15], s37 offen offset:1024 lds
    ds_read_b64_tr_b16 v[128:129], v224 offset:8192
    ds_read_b64_tr_b16 v[130:131], v224 offset:8704
    s_waitcnt lgkmcnt(10)
    v_mfma_f32_32x32x16_bf16 v[208:223], v[140:143], v[72:75], v[208:223]
    ds_read_b64_tr_b16 v[132:133], v225 offset:8192
    ds_read_b64_tr_b16 v[134:135], v225 offset:8704
    s_waitcnt lgkmcnt(10)
    v_mfma_f32_32x32x16_bf16 v[160:175], v[144:147], v[76:79], v[160:175]
    s_add_u32 s37, s36, 16384
    s_add_u32 m0, s42, 49152
    s_nop 0
    buffer_load_dwordx4 v236, s[12:15], s37 offen lds
    ds_read_b64_tr_b16 v[136:137], v226 offset:8192
    ds_read_b64_tr_b16 v[138:139], v226 offset:8704
    s_waitcnt lgkmcnt(10)
    v_mfma_f32_32x32x16_bf16 v[176:191], v[148:151], v[76:79], v[176:191]
    ds_read_b64_tr_b16 v[140:141], v227 offset:8192
    ds_read_b64_tr_b16 v[142:143], v227 offset:8704
    s_waitcnt lgkmcnt(10)
    v_mfma_f32_32x32x16_bf16 v[192:207], v[152:155], v[76:79], v[192:207]
    buffer_load_dwordx4 v237, s[12:15], s37 offen offset:1024 lds
    ds_read_b64_tr_b16 v[144:145], v224 offset:10240
    ds_read_b64_tr_b16 v[146:147], v224 offset:10752
    s_waitcnt lgkmcnt(10)
    v_mfma_f32_32x32x16_bf16 v[208:223], v[156:159], v[76:79], v[208:223]
    ds_read_b64_tr_b16 v[148:149], v225 offset:10240
    ds_read_b64_tr_b16 v[150:151], v225 offset:10752
    s_waitcnt lgkmcnt(10)
    v_mfma_f32_32x32x16_bf16 v[160:175], v[128:131], v[80:83], v[160:175]
    ds_read_b64_tr_b16 v[152:153], v226 offset:10240
    ds_read_b64_tr_b16 v[154:155], v226 offset:10752
    s_waitcnt lgkmcnt(10)
    v_mfma_f32_32x32x16_bf16 v[176:191], v[132:135], v[80:83], v[176:191]
    ds_read_b64_tr_b16 v[156:157], v227 offset:10240
    ds_read_b64_tr_b16 v[158:159], v227 offset:10752
    s_waitcnt lgkmcnt(10)
    v_mfma_f32_32x32x16_bf16 v[192:207], v[136:139], v[80:83], v[192:207]
    ds_read_b64_tr_b16 v[128:129], v224 offset:12288
    ds_read_b64_tr_b16 v[130:131], v224 offset:12800
    s_waitcnt lgkmcnt(10)
    v_mfma_f32_32x32x16_bf16 v[208:223], v[140:143], v[80:83], v[208:223]
    ds_read_b64_tr_b16 v[132:133], v225 offset:12288
    ds_read_b64_tr_b16 v[134:135], v225 offset:12800
    s_waitcnt lgkmcnt(10)
    v_mfma_f32_32x32x16_bf16 v[160:175], v[144:147], v[84:87], v[160:175]
    ds_read_b64_tr_b16 v[136:137], v226 offset:12288
    ds_read_b64_tr_b16 v[138:139], v226 offset:12800
    s_waitcnt lgkmcnt(10)
    v_mfma_f32_32x32x16_bf16 v[176:191], v[148:151], v[84:87], v[176:191]
    ds_read_b64_tr_b16 v[140:141], v227 offset:12288
    ds_read_b64_tr_b16 v[142:143], v227 offset:12800
    s_waitcnt lgkmcnt(10)
    v_mfma_f32_32x32x16_bf16 v[192:207], v[152:155], v[84:87], v[192:207]
    ds_read_b64_tr_b16 v[144:145], v224 offset:14336
    ds_read_b64_tr_b16 v[146:147], v224 offset:14848
    s_waitcnt lgkmcnt(10)
    v_mfma_f32_32x32x16_bf16 v[208:223], v[156:159], v[84:87], v[208:223]
    ds_read_b64_tr_b16 v[148:149], v225 offset:14336
    ds_read_b64_tr_b16 v[150:151], v225 offset:14848
    s_waitcnt lgkmcnt(10)
    v_mfma_f32_32x32x16_bf16 v[160:175], v[128:131], v[88:91], v[160:175]
    ds_read_b64_tr_b16 v[152:153], v226 offset:14336
    ds_read_b64_tr_b16 v[154:155], v226 offset:14848
    s_waitcnt lgkmcnt(10)
    v_mfma_f32_32x32x16_bf16 v[176:191], v[132:135], v[88:91], v[176:191]
    ds_read_b64_tr_b16 v[156:157], v227 offset:14336
    ds_read_b64_tr_b16 v[158:159], v227 offset:14848
    s_waitcnt lgkmcnt(10)
    v_mfma_f32_32x32x16_bf16 v[192:207], v[136:139], v[88:91], v[192:207]
    s_waitcnt lgkmcnt(8)
    v_mfma_f32_32x32x16_bf16 v[208:223], v[140:143], v[88:91], v[208:223]
    s_waitcnt lgkmcnt(6)
    v_mfma_f32_32x32x16_bf16 v[160:175], v[144:147], v[92:95], v[160:175]
    s_waitcnt lgkmcnt(4)
    v_mfma_f32_32x32x16_bf16 v[176:191], v[148:151], v[92:95], v[176:191]
    s_waitcnt lgkmcnt(2)
    v_mfma_f32_32x32x16_bf16 v[192:207], v[152:155], v[92:95], v[192:207]
    s_waitcnt lgkmcnt(0)
    v_mfma_f32_32x32x16_bf16 v[208:223], v[156:159], v[92:95], v[208:223]
    s_waitcnt vmcnt(12)
    s_barrier
    ds_read_b64_tr_b16 v[128:129], v224 offset:32768
    ds_read_b64_tr_b16 v[130:131], v224 offset:33280
    ds_read_b64_tr_b16 v[132:133], v225 offset:32768
    ds_read_b64_tr_b16 v[134:135], v225 offset:33280
    ds_read_b64_tr_b16 v[136:137], v226 offset:32768
    ds_read_b64_tr_b16 v[138:139], v226 offset:33280
    ds_read_b64_tr_b16 v[140:141], v227 offset:32768
    ds_read_b64_tr_b16 v[142:143], v227 offset:33280
    ds_read_b64_tr_b16 v[144:145], v224 offset:34816
    ds_read_b64_tr_b16 v[146:147], v224 offset:35328
    ds_read_b64_tr_b16 v[148:149], v225 offset:34816
    ds_read_b64_tr_b16 v[150:151], v225 offset:35328
    s_waitcnt lgkmcnt(10)
    v_mfma_f32_32x32x16_bf16 v[160:175], v[128:131], v[96:99], v[160:175]
    s_add_u32 s37, s86, 2097152
    s_add_u32 m0, s47, 65536
    s_nop 0
    buffer_load_dwordx4 v254, s[20:23], s37 offen lds
    ds_read_b64_tr_b16 v[152:153], v226 offset:34816
    ds_read_b64_tr_b16 v[154:155], v226 offset:35328
    s_waitcnt lgkmcnt(10)
    v_mfma_f32_32x32x16_bf16 v[176:191], v[132:135], v[96:99], v[176:191]
    ds_read_b64_tr_b16 v[156:157], v227 offset:34816
    ds_read_b64_tr_b16 v[158:159], v227 offset:35328
    s_waitcnt lgkmcnt(10)
    v_mfma_f32_32x32x16_bf16 v[192:207], v[136:139], v[96:99], v[192:207]
    s_add_u32 s37, s86, 2129920
    s_add_u32 m0, s47, 66560
    s_nop 0
    buffer_load_dwordx4 v254, s[20:23], s37 offen lds
    ds_read_b64_tr_b16 v[128:129], v224 offset:36864
    ds_read_b64_tr_b16 v[130:131], v224 offset:37376
    s_waitcnt lgkmcnt(10)
    v_mfma_f32_32x32x16_bf16 v[208:223], v[140:143], v[96:99], v[208:223]
    ds_read_b64_tr_b16 v[132:133], v225 offset:36864
    ds_read_b64_tr_b16 v[134:135], v225 offset:37376
    s_waitcnt lgkmcnt(10)
    v_mfma_f32_32x32x16_bf16 v[160:175], v[144:147], v[100:103], v[160:175]
    s_add_u32 s37, s86, 2162688
    s_add_u32 m0, s47, 67584
    s_nop 0
    buffer_load_dwordx4 v254, s[20:23], s37 offen lds
    ds_read_b64_tr_b16 v[136:137], v226 offset:36864
    ds_read_b64_tr_b16 v[138:139], v226 offset:37376
    s_waitcnt lgkmcnt(10)
    v_mfma_f32_32x32x16_bf16 v[176:191], v[148:151], v[100:103], v[176:191]
    ds_read_b64_tr_b16 v[140:141], v227 offset:36864
    ds_read_b64_tr_b16 v[142:143], v227 offset:37376
    s_waitcnt lgkmcnt(10)
    v_mfma_f32_32x32x16_bf16 v[192:207], v[152:155], v[100:103], v[192:207]
    s_add_u32 s37, s86, 2195456
    s_add_u32 m0, s47, 68608
    s_nop 0
    buffer_load_dwordx4 v254, s[20:23], s37 offen lds
    ds_read_b64_tr_b16 v[144:145], v224 offset:38912
    ds_read_b64_tr_b16 v[146:147], v224 offset:39424
    s_waitcnt lgkmcnt(10)
    v_mfma_f32_32x32x16_bf16 v[208:223], v[156:159], v[100:103], v[208:223]
    ds_read_b64_tr_b16 v[148:149], v225 offset:38912
    ds_read_b64_tr_b16 v[150:151], v225 offset:39424
    s_waitcnt lgkmcnt(10)
    v_mfma_f32_32x32x16_bf16 v[160:175], v[128:131], v[104:107], v[160:175]
    ds_read_b64_tr_b16 v[152:153], v226 offset:38912
    ds_read_b64_tr_b16 v[154:155], v226 offset:39424
    s_waitcnt lgkmcnt(10)
    v_mfma_f32_32x32x16_bf16 v[176:191], v[132:135], v[104:107], v[176:191]
    ds_read_b64_tr_b16 v[156:157], v227 offset:38912
    ds_read_b64_tr_b16 v[158:159], v227 offset:39424
    s_waitcnt lgkmcnt(10)
    v_mfma_f32_32x32x16_bf16 v[192:207], v[136:139], v[104:107], v[192:207]
    ds_read_b64_tr_b16 v[128:129], v224 offset:40960
    ds_read_b64_tr_b16 v[130:131], v224 offset:41472
    s_waitcnt lgkmcnt(10)
    v_mfma_f32_32x32x16_bf16 v[208:223], v[140:143], v[104:107], v[208:223]
    ds_read_b64_tr_b16 v[132:133], v225 offset:40960
    ds_read_b64_tr_b16 v[134:135], v225 offset:41472
    s_waitcnt lgkmcnt(10)
    v_mfma_f32_32x32x16_bf16 v[160:175], v[144:147], v[108:111], v[160:175]
    ds_read_b64_tr_b16 v[136:137], v226 offset:40960
    ds_read_b64_tr_b16 v[138:139], v226 offset:41472
    s_waitcnt lgkmcnt(10)
    v_mfma_f32_32x32x16_bf16 v[176:191], v[148:151], v[108:111], v[176:191]
    ds_read_b64_tr_b16 v[140:141], v227 offset:40960
    ds_read_b64_tr_b16 v[142:143], v227 offset:41472
    s_waitcnt lgkmcnt(10)
    v_mfma_f32_32x32x16_bf16 v[192:207], v[152:155], v[108:111], v[192:207]
    ds_read_b64_tr_b16 v[144:145], v224 offset:43008
    ds_read_b64_tr_b16 v[146:147], v224 offset:43520
    s_waitcnt lgkmcnt(10)
    v_mfma_f32_32x32x16_bf16 v[208:223], v[156:159], v[108:111], v[208:223]
    ds_read_b64_tr_b16 v[148:149], v225 offset:43008
    ds_read_b64_tr_b16 v[150:151], v225 offset:43520
    s_waitcnt lgkmcnt(10)
    v_mfma_f32_32x32x16_bf16 v[160:175], v[128:131], v[112:115], v[160:175]
    ds_read_b64_tr_b16 v[152:153], v226 offset:43008
    ds_read_b64_tr_b16 v[154:155], v226 offset:43520
    s_waitcnt lgkmcnt(10)
    v_mfma_f32_32x32x16_bf16 v[176:191], v[132:135], v[112:115], v[176:191]
    ds_read_b64_tr_b16 v[156:157], v227 offset:43008
    ds_read_b64_tr_b16 v[158:159], v227 offset:43520
    s_waitcnt lgkmcnt(10)
    v_mfma_f32_32x32x16_bf16 v[192:207], v[136:139], v[112:115], v[192:207]
    ds_read_b64_tr_b16 v[128:129], v224 offset:45056
    ds_read_b64_tr_b16 v[130:131], v224 offset:45568
    s_waitcnt lgkmcnt(10)
    v_mfma_f32_32x32x16_bf16 v[208:223], v[140:143], v[112:115], v[208:223]
    ds_read_b64_tr_b16 v[132:133], v225 offset:45056
    ds_read_b64_tr_b16 v[134:135], v225 offset:45568
    s_waitcnt lgkmcnt(10)
    v_mfma_f32_32x32x16_bf16 v[160:175], v[144:147], v[116:119], v[160:175]
    ds_read_b64_tr_b16 v[136:137], v226 offset:45056
    ds_read_b64_tr_b16 v[138:139], v226 offset:45568
    s_waitcnt lgkmcnt(10)
    v_mfma_f32_32x32x16_bf16 v[176:191], v[148:151], v[116:119], v[176:191]
    ds_read_b64_tr_b16 v[140:141], v227 offset:45056
    ds_read_b64_tr_b16 v[142:143], v227 offset:45568
    s_waitcnt lgkmcnt(10)
    v_mfma_f32_32x32x16_bf16 v[192:207], v[152:155], v[116:119], v[192:207]
    ds_read_b64_tr_b16 v[144:145], v224 offset:47104
    ds_read_b64_tr_b16 v[146:147], v224 offset:47616
    s_waitcnt lgkmcnt(10)
    v_mfma_f32_32x32x16_bf16 v[208:223], v[156:159], v[116:119], v[208:223]
    ds_read_b64_tr_b16 v[148:149], v225 offset:47104
    ds_read_b64_tr_b16 v[150:151], v225 offset:47616
    s_waitcnt lgkmcnt(10)
    v_mfma_f32_32x32x16_bf16 v[160:175], v[128:131], v[120:123], v[160:175]
    ds_read_b64_tr_b16 v[152:153], v226 offset:47104
    ds_read_b64_tr_b16 v[154:155], v226 offset:47616
    s_waitcnt lgkmcnt(10)
    v_mfma_f32_32x32x16_bf16 v[176:191], v[132:135], v[120:123], v[176:191]
    ds_read_b64_tr_b16 v[156:157], v227 offset:47104
    ds_read_b64_tr_b16 v[158:159], v227 offset:47616
    s_waitcnt lgkmcnt(10)
    v_mfma_f32_32x32x16_bf16 v[192:207], v[136:139], v[120:123], v[192:207]
    s_waitcnt lgkmcnt(8)
    v_mfma_f32_32x32x16_bf16 v[208:223], v[140:143], v[120:123], v[208:223]
    s_waitcnt lgkmcnt(6)
    v_mfma_f32_32x32x16_bf16 v[160:175], v[144:147], v[124:127], v[160:175]
    s_waitcnt lgkmcnt(4)
    v_mfma_f32_32x32x16_bf16 v[176:191], v[148:151], v[124:127], v[176:191]
    s_waitcnt lgkmcnt(2)
    v_mfma_f32_32x32x16_bf16 v[192:207], v[152:155], v[124:127], v[192:207]
    s_waitcnt lgkmcnt(0)
    v_mfma_f32_32x32x16_bf16 v[208:223], v[156:159], v[124:127], v[208:223]
    s_nop 15
    s_nop 3
    s_mov_b32 s37, 0xbdd2d3e8
    v_mov_b32 v247, 0xc0135761
    v_cvt_pk_bf16_f32 v243, v160, v161
    v_lshlrev_b32 v160, 16, v243
    v_and_b32 v161, 0xffff0000, v243
    v_cvt_pk_bf16_f32 v243, v192, v193
    v_lshlrev_b32 v192, 16, v243
    v_and_b32 v193, 0xffff0000, v243
    v_mul_f32 v243, v160, v160
    v_fma_f32 v243, v243, s37, v247
    v_mul_f32 v243, v243, v160
    v_mul_f32 v244, v161, v161
    v_fma_f32 v244, v244, s37, v247
    v_mul_f32 v244, v244, v161
    v_exp_f32 v243, v243
    v_exp_f32 v244, v244
    s_nop 0
    v_add_f32 v243, 1.0, v243
    v_add_f32 v244, 1.0, v244
    v_rcp_f32 v243, v243
    v_rcp_f32 v244, v244
    s_nop 0
    v_mul_f32 v160, v160, v243
    v_mul_f32 v161, v161, v244
    v_cvt_pk_bf16_f32 v243, v160, v161
    v_lshlrev_b32 v160, 16, v243
    v_and_b32 v161, 0xffff0000, v243
    v_mul_f32 v160, v160, v192
    v_mul_f32 v161, v161, v193
    v_cvt_pk_bf16_f32 v160, v160, v161
    v_cvt_pk_bf16_f32 v243, v162, v163
    v_lshlrev_b32 v162, 16, v243
    v_and_b32 v163, 0xffff0000, v243
    v_cvt_pk_bf16_f32 v243, v194, v195
    v_lshlrev_b32 v194, 16, v243
    v_and_b32 v195, 0xffff0000, v243
    v_mul_f32 v243, v162, v162
    v_fma_f32 v243, v243, s37, v247
    v_mul_f32 v243, v243, v162
    v_mul_f32 v244, v163, v163
    v_fma_f32 v244, v244, s37, v247
    v_mul_f32 v244, v244, v163
    v_exp_f32 v243, v243
    v_exp_f32 v244, v244
    s_nop 0
    v_add_f32 v243, 1.0, v243
    v_add_f32 v244, 1.0, v244
    v_rcp_f32 v243, v243
    v_rcp_f32 v244, v244
    s_nop 0
    v_mul_f32 v162, v162, v243
    v_mul_f32 v163, v163, v244
    v_cvt_pk_bf16_f32 v243, v162, v163
    v_lshlrev_b32 v162, 16, v243
    v_and_b32 v163, 0xffff0000, v243
    v_mul_f32 v162, v162, v194
    v_mul_f32 v163, v163, v195
    v_cvt_pk_bf16_f32 v161, v162, v163
    v_cvt_pk_bf16_f32 v243, v164, v165
    v_lshlrev_b32 v164, 16, v243
    v_and_b32 v165, 0xffff0000, v243
    v_cvt_pk_bf16_f32 v243, v196, v197
    v_lshlrev_b32 v196, 16, v243
    v_and_b32 v197, 0xffff0000, v243
    v_mul_f32 v243, v164, v164
    v_fma_f32 v243, v243, s37, v247
    v_mul_f32 v243, v243, v164
    v_mul_f32 v244, v165, v165
    v_fma_f32 v244, v244, s37, v247
    v_mul_f32 v244, v244, v165
    v_exp_f32 v243, v243
    v_exp_f32 v244, v244
    s_nop 0
    v_add_f32 v243, 1.0, v243
    v_add_f32 v244, 1.0, v244
    v_rcp_f32 v243, v243
    v_rcp_f32 v244, v244
    s_nop 0
    v_mul_f32 v164, v164, v243
    v_mul_f32 v165, v165, v244
    v_cvt_pk_bf16_f32 v243, v164, v165
    v_lshlrev_b32 v164, 16, v243
    v_and_b32 v165, 0xffff0000, v243
    v_mul_f32 v164, v164, v196
    v_mul_f32 v165, v165, v197
    v_cvt_pk_bf16_f32 v162, v164, v165
    v_cvt_pk_bf16_f32 v243, v166, v167
    v_lshlrev_b32 v166, 16, v243
    v_and_b32 v167, 0xffff0000, v243
    v_cvt_pk_bf16_f32 v243, v198, v199
    v_lshlrev_b32 v198, 16, v243
    v_and_b32 v199, 0xffff0000, v243
    v_mul_f32 v243, v166, v166
    v_fma_f32 v243, v243, s37, v247
    v_mul_f32 v243, v243, v166
    v_mul_f32 v244, v167, v167
    v_fma_f32 v244, v244, s37, v247
    v_mul_f32 v244, v244, v167
    v_exp_f32 v243, v243
    v_exp_f32 v244, v244
    s_nop 0
    v_add_f32 v243, 1.0, v243
    v_add_f32 v244, 1.0, v244
    v_rcp_f32 v243, v243
    v_rcp_f32 v244, v244
    s_nop 0
    v_mul_f32 v166, v166, v243
    v_mul_f32 v167, v167, v244
    v_cvt_pk_bf16_f32 v243, v166, v167
    v_lshlrev_b32 v166, 16, v243
    v_and_b32 v167, 0xffff0000, v243
    v_mul_f32 v166, v166, v198
    v_mul_f32 v167, v167, v199
    v_cvt_pk_bf16_f32 v163, v166, v167
    v_cvt_pk_bf16_f32 v243, v168, v169
    v_lshlrev_b32 v168, 16, v243
    v_and_b32 v169, 0xffff0000, v243
    v_cvt_pk_bf16_f32 v243, v200, v201
    v_lshlrev_b32 v200, 16, v243
    v_and_b32 v201, 0xffff0000, v243
    v_mul_f32 v243, v168, v168
    v_fma_f32 v243, v243, s37, v247
    v_mul_f32 v243, v243, v168
    v_mul_f32 v244, v169, v169
    v_fma_f32 v244, v244, s37, v247
    v_mul_f32 v244, v244, v169
    v_exp_f32 v243, v243
    v_exp_f32 v244, v244
    s_nop 0
    v_add_f32 v243, 1.0, v243
    v_add_f32 v244, 1.0, v244
    v_rcp_f32 v243, v243
    v_rcp_f32 v244, v244
    s_nop 0
    v_mul_f32 v168, v168, v243
    v_mul_f32 v169, v169, v244
    v_cvt_pk_bf16_f32 v243, v168, v169
    v_lshlrev_b32 v168, 16, v243
    v_and_b32 v169, 0xffff0000, v243
    v_mul_f32 v168, v168, v200
    v_mul_f32 v169, v169, v201
    v_cvt_pk_bf16_f32 v164, v168, v169
    v_cvt_pk_bf16_f32 v243, v170, v171
    v_lshlrev_b32 v170, 16, v243
    v_and_b32 v171, 0xffff0000, v243
    v_cvt_pk_bf16_f32 v243, v202, v203
    v_lshlrev_b32 v202, 16, v243
    v_and_b32 v203, 0xffff0000, v243
    v_mul_f32 v243, v170, v170
    v_fma_f32 v243, v243, s37, v247
    v_mul_f32 v243, v243, v170
    v_mul_f32 v244, v171, v171
    v_fma_f32 v244, v244, s37, v247
    v_mul_f32 v244, v244, v171
    v_exp_f32 v243, v243
    v_exp_f32 v244, v244
    s_nop 0
    v_add_f32 v243, 1.0, v243
    v_add_f32 v244, 1.0, v244
    v_rcp_f32 v243, v243
    v_rcp_f32 v244, v244
    s_nop 0
    v_mul_f32 v170, v170, v243
    v_mul_f32 v171, v171, v244
    v_cvt_pk_bf16_f32 v243, v170, v171
    v_lshlrev_b32 v170, 16, v243
    v_and_b32 v171, 0xffff0000, v243
    v_mul_f32 v170, v170, v202
    v_mul_f32 v171, v171, v203
    v_cvt_pk_bf16_f32 v165, v170, v171
    v_cvt_pk_bf16_f32 v243, v172, v173
    v_lshlrev_b32 v172, 16, v243
    v_and_b32 v173, 0xffff0000, v243
    v_cvt_pk_bf16_f32 v243, v204, v205
    v_lshlrev_b32 v204, 16, v243
    v_and_b32 v205, 0xffff0000, v243
    v_mul_f32 v243, v172, v172
    v_fma_f32 v243, v243, s37, v247
    v_mul_f32 v243, v243, v172
    v_mul_f32 v244, v173, v173
    v_fma_f32 v244, v244, s37, v247
    v_mul_f32 v244, v244, v173
    v_exp_f32 v243, v243
    v_exp_f32 v244, v244
    s_nop 0
    v_add_f32 v243, 1.0, v243
    v_add_f32 v244, 1.0, v244
    v_rcp_f32 v243, v243
    v_rcp_f32 v244, v244
    s_nop 0
    v_mul_f32 v172, v172, v243
    v_mul_f32 v173, v173, v244
    v_cvt_pk_bf16_f32 v243, v172, v173
    v_lshlrev_b32 v172, 16, v243
    v_and_b32 v173, 0xffff0000, v243
    v_mul_f32 v172, v172, v204
    v_mul_f32 v173, v173, v205
    v_cvt_pk_bf16_f32 v166, v172, v173
    v_cvt_pk_bf16_f32 v243, v174, v175
    v_lshlrev_b32 v174, 16, v243
    v_and_b32 v175, 0xffff0000, v243
    v_cvt_pk_bf16_f32 v243, v206, v207
    v_lshlrev_b32 v206, 16, v243
    v_and_b32 v207, 0xffff0000, v243
    v_mul_f32 v243, v174, v174
    v_fma_f32 v243, v243, s37, v247
    v_mul_f32 v243, v243, v174
    v_mul_f32 v244, v175, v175
    v_fma_f32 v244, v244, s37, v247
    v_mul_f32 v244, v244, v175
    v_exp_f32 v243, v243
    v_exp_f32 v244, v244
    s_nop 0
    v_add_f32 v243, 1.0, v243
    v_add_f32 v244, 1.0, v244
    v_rcp_f32 v243, v243
    v_rcp_f32 v244, v244
    s_nop 0
    v_mul_f32 v174, v174, v243
    v_mul_f32 v175, v175, v244
    v_cvt_pk_bf16_f32 v243, v174, v175
    v_lshlrev_b32 v174, 16, v243
    v_and_b32 v175, 0xffff0000, v243
    v_mul_f32 v174, v174, v206
    v_mul_f32 v175, v175, v207
    v_cvt_pk_bf16_f32 v167, v174, v175
    buffer_store_dwordx4 v[160:163], v249, s[56:59], s87 offen offset:0
    buffer_store_dwordx4 v[164:167], v249, s[56:59], s87 offen offset:1024
    v_cvt_pk_bf16_f32 v243, v176, v177
    v_lshlrev_b32 v176, 16, v243
    v_and_b32 v177, 0xffff0000, v243
    v_cvt_pk_bf16_f32 v243, v208, v209
    v_lshlrev_b32 v208, 16, v243
    v_and_b32 v209, 0xffff0000, v243
    v_mul_f32 v243, v176, v176
    v_fma_f32 v243, v243, s37, v247
    v_mul_f32 v243, v243, v176
    v_mul_f32 v244, v177, v177
    v_fma_f32 v244, v244, s37, v247
    v_mul_f32 v244, v244, v177
    v_exp_f32 v243, v243
    v_exp_f32 v244, v244
    s_nop 0
    v_add_f32 v243, 1.0, v243
    v_add_f32 v244, 1.0, v244
    v_rcp_f32 v243, v243
    v_rcp_f32 v244, v244
    s_nop 0
    v_mul_f32 v176, v176, v243
    v_mul_f32 v177, v177, v244
    v_cvt_pk_bf16_f32 v243, v176, v177
    v_lshlrev_b32 v176, 16, v243
    v_and_b32 v177, 0xffff0000, v243
    v_mul_f32 v176, v176, v208
    v_mul_f32 v177, v177, v209
    v_cvt_pk_bf16_f32 v176, v176, v177
    v_cvt_pk_bf16_f32 v243, v178, v179
    v_lshlrev_b32 v178, 16, v243
    v_and_b32 v179, 0xffff0000, v243
    v_cvt_pk_bf16_f32 v243, v210, v211
    v_lshlrev_b32 v210, 16, v243
    v_and_b32 v211, 0xffff0000, v243
    v_mul_f32 v243, v178, v178
    v_fma_f32 v243, v243, s37, v247
    v_mul_f32 v243, v243, v178
    v_mul_f32 v244, v179, v179
    v_fma_f32 v244, v244, s37, v247
    v_mul_f32 v244, v244, v179
    v_exp_f32 v243, v243
    v_exp_f32 v244, v244
    s_nop 0
    v_add_f32 v243, 1.0, v243
    v_add_f32 v244, 1.0, v244
    v_rcp_f32 v243, v243
    v_rcp_f32 v244, v244
    s_nop 0
    v_mul_f32 v178, v178, v243
    v_mul_f32 v179, v179, v244
    v_cvt_pk_bf16_f32 v243, v178, v179
    v_lshlrev_b32 v178, 16, v243
    v_and_b32 v179, 0xffff0000, v243
    v_mul_f32 v178, v178, v210
    v_mul_f32 v179, v179, v211
    v_cvt_pk_bf16_f32 v177, v178, v179
    v_cvt_pk_bf16_f32 v243, v180, v181
    v_lshlrev_b32 v180, 16, v243
    v_and_b32 v181, 0xffff0000, v243
    v_cvt_pk_bf16_f32 v243, v212, v213
    v_lshlrev_b32 v212, 16, v243
    v_and_b32 v213, 0xffff0000, v243
    v_mul_f32 v243, v180, v180
    v_fma_f32 v243, v243, s37, v247
    v_mul_f32 v243, v243, v180
    v_mul_f32 v244, v181, v181
    v_fma_f32 v244, v244, s37, v247
    v_mul_f32 v244, v244, v181
    v_exp_f32 v243, v243
    v_exp_f32 v244, v244
    s_nop 0
    v_add_f32 v243, 1.0, v243
    v_add_f32 v244, 1.0, v244
    v_rcp_f32 v243, v243
    v_rcp_f32 v244, v244
    s_nop 0
    v_mul_f32 v180, v180, v243
    v_mul_f32 v181, v181, v244
    v_cvt_pk_bf16_f32 v243, v180, v181
    v_lshlrev_b32 v180, 16, v243
    v_and_b32 v181, 0xffff0000, v243
    v_mul_f32 v180, v180, v212
    v_mul_f32 v181, v181, v213
    v_cvt_pk_bf16_f32 v178, v180, v181
    v_cvt_pk_bf16_f32 v243, v182, v183
    v_lshlrev_b32 v182, 16, v243
    v_and_b32 v183, 0xffff0000, v243
    v_cvt_pk_bf16_f32 v243, v214, v215
    v_lshlrev_b32 v214, 16, v243
    v_and_b32 v215, 0xffff0000, v243
    v_mul_f32 v243, v182, v182
    v_fma_f32 v243, v243, s37, v247
    v_mul_f32 v243, v243, v182
    v_mul_f32 v244, v183, v183
    v_fma_f32 v244, v244, s37, v247
    v_mul_f32 v244, v244, v183
    v_exp_f32 v243, v243
    v_exp_f32 v244, v244
    s_nop 0
    v_add_f32 v243, 1.0, v243
    v_add_f32 v244, 1.0, v244
    v_rcp_f32 v243, v243
    v_rcp_f32 v244, v244
    s_nop 0
    v_mul_f32 v182, v182, v243
    v_mul_f32 v183, v183, v244
    v_cvt_pk_bf16_f32 v243, v182, v183
    v_lshlrev_b32 v182, 16, v243
    v_and_b32 v183, 0xffff0000, v243
    v_mul_f32 v182, v182, v214
    v_mul_f32 v183, v183, v215
    v_cvt_pk_bf16_f32 v179, v182, v183
    v_cvt_pk_bf16_f32 v243, v184, v185
    v_lshlrev_b32 v184, 16, v243
    v_and_b32 v185, 0xffff0000, v243
    v_cvt_pk_bf16_f32 v243, v216, v217
    v_lshlrev_b32 v216, 16, v243
    v_and_b32 v217, 0xffff0000, v243
    v_mul_f32 v243, v184, v184
    v_fma_f32 v243, v243, s37, v247
    v_mul_f32 v243, v243, v184
    v_mul_f32 v244, v185, v185
    v_fma_f32 v244, v244, s37, v247
    v_mul_f32 v244, v244, v185
    v_exp_f32 v243, v243
    v_exp_f32 v244, v244
    s_nop 0
    v_add_f32 v243, 1.0, v243
    v_add_f32 v244, 1.0, v244
    v_rcp_f32 v243, v243
    v_rcp_f32 v244, v244
    s_nop 0
    v_mul_f32 v184, v184, v243
    v_mul_f32 v185, v185, v244
    v_cvt_pk_bf16_f32 v243, v184, v185
    v_lshlrev_b32 v184, 16, v243
    v_and_b32 v185, 0xffff0000, v243
    v_mul_f32 v184, v184, v216
    v_mul_f32 v185, v185, v217
    v_cvt_pk_bf16_f32 v180, v184, v185
    v_cvt_pk_bf16_f32 v243, v186, v187
    v_lshlrev_b32 v186, 16, v243
    v_and_b32 v187, 0xffff0000, v243
    v_cvt_pk_bf16_f32 v243, v218, v219
    v_lshlrev_b32 v218, 16, v243
    v_and_b32 v219, 0xffff0000, v243
    v_mul_f32 v243, v186, v186
    v_fma_f32 v243, v243, s37, v247
    v_mul_f32 v243, v243, v186
    v_mul_f32 v244, v187, v187
    v_fma_f32 v244, v244, s37, v247
    v_mul_f32 v244, v244, v187
    v_exp_f32 v243, v243
    v_exp_f32 v244, v244
    s_nop 0
    v_add_f32 v243, 1.0, v243
    v_add_f32 v244, 1.0, v244
    v_rcp_f32 v243, v243
    v_rcp_f32 v244, v244
    s_nop 0
    v_mul_f32 v186, v186, v243
    v_mul_f32 v187, v187, v244
    v_cvt_pk_bf16_f32 v243, v186, v187
    v_lshlrev_b32 v186, 16, v243
    v_and_b32 v187, 0xffff0000, v243
    v_mul_f32 v186, v186, v218
    v_mul_f32 v187, v187, v219
    v_cvt_pk_bf16_f32 v181, v186, v187
    v_cvt_pk_bf16_f32 v243, v188, v189
    v_lshlrev_b32 v188, 16, v243
    v_and_b32 v189, 0xffff0000, v243
    v_cvt_pk_bf16_f32 v243, v220, v221
    v_lshlrev_b32 v220, 16, v243
    v_and_b32 v221, 0xffff0000, v243
    v_mul_f32 v243, v188, v188
    v_fma_f32 v243, v243, s37, v247
    v_mul_f32 v243, v243, v188
    v_mul_f32 v244, v189, v189
    v_fma_f32 v244, v244, s37, v247
    v_mul_f32 v244, v244, v189
    v_exp_f32 v243, v243
    v_exp_f32 v244, v244
    s_nop 0
    v_add_f32 v243, 1.0, v243
    v_add_f32 v244, 1.0, v244
    v_rcp_f32 v243, v243
    v_rcp_f32 v244, v244
    s_nop 0
    v_mul_f32 v188, v188, v243
    v_mul_f32 v189, v189, v244
    v_cvt_pk_bf16_f32 v243, v188, v189
    v_lshlrev_b32 v188, 16, v243
    v_and_b32 v189, 0xffff0000, v243
    v_mul_f32 v188, v188, v220
    v_mul_f32 v189, v189, v221
    v_cvt_pk_bf16_f32 v182, v188, v189
    v_cvt_pk_bf16_f32 v243, v190, v191
    v_lshlrev_b32 v190, 16, v243
    v_and_b32 v191, 0xffff0000, v243
    v_cvt_pk_bf16_f32 v243, v222, v223
    v_lshlrev_b32 v222, 16, v243
    v_and_b32 v223, 0xffff0000, v243
    v_mul_f32 v243, v190, v190
    v_fma_f32 v243, v243, s37, v247
    v_mul_f32 v243, v243, v190
    v_mul_f32 v244, v191, v191
    v_fma_f32 v244, v244, s37, v247
    v_mul_f32 v244, v244, v191
    v_exp_f32 v243, v243
    v_exp_f32 v244, v244
    s_nop 0
    v_add_f32 v243, 1.0, v243
    v_add_f32 v244, 1.0, v244
    v_rcp_f32 v243, v243
    v_rcp_f32 v244, v244
    s_nop 0
    v_mul_f32 v190, v190, v243
    v_mul_f32 v191, v191, v244
    v_cvt_pk_bf16_f32 v243, v190, v191
    v_lshlrev_b32 v190, 16, v243
    v_and_b32 v191, 0xffff0000, v243
    v_mul_f32 v190, v190, v222
    v_mul_f32 v191, v191, v223
    v_cvt_pk_bf16_f32 v183, v190, v191
    buffer_store_dwordx4 v[176:179], v249, s[56:59], s87 offen offset:2048
    buffer_store_dwordx4 v[180:183], v249, s[56:59], s87 offen offset:3072
    s_waitcnt vmcnt(16)
    s_barrier
    ds_read_b64_tr_b16 v[128:129], v250 offset:0
    ds_read_b64_tr_b16 v[130:131], v250 offset:1024
    ds_read_b64_tr_b16 v[132:133], v251 offset:0
    ds_read_b64_tr_b16 v[134:135], v251 offset:1024
    ds_read_b64_tr_b16 v[136:137], v252 offset:0
    ds_read_b64_tr_b16 v[138:139], v252 offset:1024
    ds_read_b64_tr_b16 v[140:141], v253 offset:0
    ds_read_b64_tr_b16 v[142:143], v253 offset:1024
    ds_read_b64_tr_b16 v[144:145], v250 offset:4096
    ds_read_b64_tr_b16 v[146:147], v250 offset:5120
    ds_read_b64_tr_b16 v[148:149], v251 offset:4096
    ds_read_b64_tr_b16 v[150:151], v251 offset:5120
    s_waitcnt lgkmcnt(10)
    v_mfma_f32_32x32x16_bf16 v[160:175], v[128:131], v[0:3], 0
    s_add_u32 s37, s86, 3145728
    s_add_u32 m0, s47, 98304
    s_nop 0
    buffer_load_dwordx4 v254, s[20:23], s37 offen lds
    ds_read_b64_tr_b16 v[152:153], v252 offset:4096
    ds_read_b64_tr_b16 v[154:155], v252 offset:5120
    s_waitcnt lgkmcnt(10)
    v_mfma_f32_32x32x16_bf16 v[176:191], v[132:135], v[0:3], 0
    ds_read_b64_tr_b16 v[156:157], v253 offset:4096
    ds_read_b64_tr_b16 v[158:159], v253 offset:5120
    s_waitcnt lgkmcnt(10)
    v_mfma_f32_32x32x16_bf16 v[192:207], v[136:139], v[0:3], 0
    s_add_u32 s37, s86, 3178496
    s_add_u32 m0, s47, 99328
    s_nop 0
    buffer_load_dwordx4 v254, s[20:23], s37 offen lds
    ds_read_b64_tr_b16 v[128:129], v250 offset:8192
    ds_read_b64_tr_b16 v[130:131], v250 offset:9216
    s_waitcnt lgkmcnt(10)
    v_mfma_f32_32x32x16_bf16 v[208:223], v[140:143], v[0:3], 0
    ds_read_b64_tr_b16 v[132:133], v251 offset:8192
    ds_read_b64_tr_b16 v[134:135], v251 offset:9216
    s_waitcnt lgkmcnt(10)
    v_mfma_f32_32x32x16_bf16 v[160:175], v[144:147], v[4:7], v[160:175]
    s_add_u32 s37, s86, 3211264
    s_add_u32 m0, s47, 100352
    s_nop 0
    buffer_load_dwordx4 v254, s[20:23], s37 offen lds
    ds_read_b64_tr_b16 v[136:137], v252 offset:8192
    ds_read_b64_tr_b16 v[138:139], v252 offset:9216
    s_waitcnt lgkmcnt(10)
    v_mfma_f32_32x32x16_bf16 v[176:191], v[148:151], v[4:7], v[176:191]
    ds_read_b64_tr_b16 v[140:141], v253 offset:8192
    ds_read_b64_tr_b16 v[142:143], v253 offset:9216
    s_waitcnt lgkmcnt(10)
    v_mfma_f32_32x32x16_bf16 v[192:207], v[152:155], v[4:7], v[192:207]
    s_add_u32 s37, s86, 3244032
    s_add_u32 m0, s47, 101376
    s_nop 0
    buffer_load_dwordx4 v254, s[20:23], s37 offen lds
    ds_read_b64_tr_b16 v[144:145], v250 offset:12288
    ds_read_b64_tr_b16 v[146:147], v250 offset:13312
    s_waitcnt lgkmcnt(10)
    v_mfma_f32_32x32x16_bf16 v[208:223], v[156:159], v[4:7], v[208:223]
    ds_read_b64_tr_b16 v[148:149], v251 offset:12288
    ds_read_b64_tr_b16 v[150:151], v251 offset:13312
    s_waitcnt lgkmcnt(10)
    v_mfma_f32_32x32x16_bf16 v[160:175], v[128:131], v[8:11], v[160:175]
    ds_read_b64_tr_b16 v[152:153], v252 offset:12288
    ds_read_b64_tr_b16 v[154:155], v252 offset:13312
    s_waitcnt lgkmcnt(10)
    v_mfma_f32_32x32x16_bf16 v[176:191], v[132:135], v[8:11], v[176:191]
    ds_read_b64_tr_b16 v[156:157], v253 offset:12288
    ds_read_b64_tr_b16 v[158:159], v253 offset:13312
    s_waitcnt lgkmcnt(10)
    v_mfma_f32_32x32x16_bf16 v[192:207], v[136:139], v[8:11], v[192:207]
    ds_read_b64_tr_b16 v[128:129], v250 offset:16384
    ds_read_b64_tr_b16 v[130:131], v250 offset:17408
    s_waitcnt lgkmcnt(10)
    v_mfma_f32_32x32x16_bf16 v[208:223], v[140:143], v[8:11], v[208:223]
    ds_read_b64_tr_b16 v[132:133], v251 offset:16384
    ds_read_b64_tr_b16 v[134:135], v251 offset:17408
    s_waitcnt lgkmcnt(10)
    v_mfma_f32_32x32x16_bf16 v[160:175], v[144:147], v[12:15], v[160:175]
    ds_read_b64_tr_b16 v[136:137], v252 offset:16384
    ds_read_b64_tr_b16 v[138:139], v252 offset:17408
    s_waitcnt lgkmcnt(10)
    v_mfma_f32_32x32x16_bf16 v[176:191], v[148:151], v[12:15], v[176:191]
    ds_read_b64_tr_b16 v[140:141], v253 offset:16384
    ds_read_b64_tr_b16 v[142:143], v253 offset:17408
    s_waitcnt lgkmcnt(10)
    v_mfma_f32_32x32x16_bf16 v[192:207], v[152:155], v[12:15], v[192:207]
    ds_read_b64_tr_b16 v[144:145], v250 offset:20480
    ds_read_b64_tr_b16 v[146:147], v250 offset:21504
    s_waitcnt lgkmcnt(10)
    v_mfma_f32_32x32x16_bf16 v[208:223], v[156:159], v[12:15], v[208:223]
    ds_read_b64_tr_b16 v[148:149], v251 offset:20480
    ds_read_b64_tr_b16 v[150:151], v251 offset:21504
    s_waitcnt lgkmcnt(10)
    v_mfma_f32_32x32x16_bf16 v[160:175], v[128:131], v[16:19], v[160:175]
    ds_read_b64_tr_b16 v[152:153], v252 offset:20480
    ds_read_b64_tr_b16 v[154:155], v252 offset:21504
    s_waitcnt lgkmcnt(10)
    v_mfma_f32_32x32x16_bf16 v[176:191], v[132:135], v[16:19], v[176:191]
    ds_read_b64_tr_b16 v[156:157], v253 offset:20480
    ds_read_b64_tr_b16 v[158:159], v253 offset:21504
    s_waitcnt lgkmcnt(10)
    v_mfma_f32_32x32x16_bf16 v[192:207], v[136:139], v[16:19], v[192:207]
    ds_read_b64_tr_b16 v[128:129], v250 offset:24576
    ds_read_b64_tr_b16 v[130:131], v250 offset:25600
    s_waitcnt lgkmcnt(10)
    v_mfma_f32_32x32x16_bf16 v[208:223], v[140:143], v[16:19], v[208:223]
    ds_read_b64_tr_b16 v[132:133], v251 offset:24576
    ds_read_b64_tr_b16 v[134:135], v251 offset:25600
    s_waitcnt lgkmcnt(10)
    v_mfma_f32_32x32x16_bf16 v[160:175], v[144:147], v[20:23], v[160:175]
    ds_read_b64_tr_b16 v[136:137], v252 offset:24576
    ds_read_b64_tr_b16 v[138:139], v252 offset:25600
    s_waitcnt lgkmcnt(10)
    v_mfma_f32_32x32x16_bf16 v[176:191], v[148:151], v[20:23], v[176:191]
    ds_read_b64_tr_b16 v[140:141], v253 offset:24576
    ds_read_b64_tr_b16 v[142:143], v253 offset:25600
    s_waitcnt lgkmcnt(10)
    v_mfma_f32_32x32x16_bf16 v[192:207], v[152:155], v[20:23], v[192:207]
    ds_read_b64_tr_b16 v[144:145], v250 offset:28672
    ds_read_b64_tr_b16 v[146:147], v250 offset:29696
    s_waitcnt lgkmcnt(10)
    v_mfma_f32_32x32x16_bf16 v[208:223], v[156:159], v[20:23], v[208:223]
    ds_read_b64_tr_b16 v[148:149], v251 offset:28672
    ds_read_b64_tr_b16 v[150:151], v251 offset:29696
    s_waitcnt lgkmcnt(10)
    v_mfma_f32_32x32x16_bf16 v[160:175], v[128:131], v[24:27], v[160:175]
    ds_read_b64_tr_b16 v[152:153], v252 offset:28672
    ds_read_b64_tr_b16 v[154:155], v252 offset:29696
    s_waitcnt lgkmcnt(10)
    v_mfma_f32_32x32x16_bf16 v[176:191], v[132:135], v[24:27], v[176:191]
    ds_read_b64_tr_b16 v[156:157], v253 offset:28672
    ds_read_b64_tr_b16 v[158:159], v253 offset:29696
    s_waitcnt lgkmcnt(10)
    v_mfma_f32_32x32x16_bf16 v[192:207], v[136:139], v[24:27], v[192:207]
    s_waitcnt lgkmcnt(8)
    v_mfma_f32_32x32x16_bf16 v[208:223], v[140:143], v[24:27], v[208:223]
    s_waitcnt lgkmcnt(6)
    v_mfma_f32_32x32x16_bf16 v[160:175], v[144:147], v[28:31], v[160:175]
    s_waitcnt lgkmcnt(4)
    v_mfma_f32_32x32x16_bf16 v[176:191], v[148:151], v[28:31], v[176:191]
    s_waitcnt lgkmcnt(2)
    v_mfma_f32_32x32x16_bf16 v[192:207], v[152:155], v[28:31], v[192:207]
    s_waitcnt lgkmcnt(0)
    v_mfma_f32_32x32x16_bf16 v[208:223], v[156:159], v[28:31], v[208:223]
    s_waitcnt vmcnt(16)
    s_barrier
    ds_read_b64_tr_b16 v[128:129], v250 offset:32768
    ds_read_b64_tr_b16 v[130:131], v250 offset:33792
    ds_read_b64_tr_b16 v[132:133], v251 offset:32768
    ds_read_b64_tr_b16 v[134:135], v251 offset:33792
    ds_read_b64_tr_b16 v[136:137], v252 offset:32768
    ds_read_b64_tr_b16 v[138:139], v252 offset:33792
    ds_read_b64_tr_b16 v[140:141], v253 offset:32768
    ds_read_b64_tr_b16 v[142:143], v253 offset:33792
    ds_read_b64_tr_b16 v[144:145], v250 offset:36864
    ds_read_b64_tr_b16 v[146:147], v250 offset:37888
    ds_read_b64_tr_b16 v[148:149], v251 offset:36864
    ds_read_b64_tr_b16 v[150:151], v251 offset:37888
    s_waitcnt lgkmcnt(10)
    v_mfma_f32_32x32x16_bf16 v[160:175], v[128:131], v[32:35], v[160:175]
    s_add_u32 s37, s36, 0
    s_add_u32 m0, s43, 0
    s_nop 0
    buffer_load_dwordx4 v238, s[16:19], s37 offen lds
    ds_read_b64_tr_b16 v[152:153], v252 offset:36864
    ds_read_b64_tr_b16 v[154:155], v252 offset:37888
    s_waitcnt lgkmcnt(10)
    v_mfma_f32_32x32x16_bf16 v[176:191], v[132:135], v[32:35], v[176:191]
    ds_read_b64_tr_b16 v[156:157], v253 offset:36864
    ds_read_b64_tr_b16 v[158:159], v253 offset:37888
    s_waitcnt lgkmcnt(10)
    v_mfma_f32_32x32x16_bf16 v[192:207], v[136:139], v[32:35], v[192:207]
    buffer_load_dwordx4 v238, s[16:19], s37 offen offset:1024 lds
    ds_read_b64_tr_b16 v[128:129], v250 offset:40960
    ds_read_b64_tr_b16 v[130:131], v250 offset:41984
    s_waitcnt lgkmcnt(10)
    v_mfma_f32_32x32x16_bf16 v[208:223], v[140:143], v[32:35], v[208:223]
    ds_read_b64_tr_b16 v[132:133], v251 offset:40960
    ds_read_b64_tr_b16 v[134:135], v251 offset:41984
    s_waitcnt lgkmcnt(10)
    v_mfma_f32_32x32x16_bf16 v[160:175], v[144:147], v[36:39], v[160:175]
    s_add_u32 s37, s36, 16384
    s_add_u32 m0, s43, 16384
    s_nop 0
    buffer_load_dwordx4 v238, s[16:19], s37 offen lds
    ds_read_b64_tr_b16 v[136:137], v252 offset:40960
    ds_read_b64_tr_b16 v[138:139], v252 offset:41984
    s_waitcnt lgkmcnt(10)
    v_mfma_f32_32x32x16_bf16 v[176:191], v[148:151], v[36:39], v[176:191]
    ds_read_b64_tr_b16 v[140:141], v253 offset:40960
    ds_read_b64_tr_b16 v[142:143], v253 offset:41984
    s_waitcnt lgkmcnt(10)
    v_mfma_f32_32x32x16_bf16 v[192:207], v[152:155], v[36:39], v[192:207]
    buffer_load_dwordx4 v238, s[16:19], s37 offen offset:1024 lds
    ds_read_b64_tr_b16 v[144:145], v250 offset:45056
    ds_read_b64_tr_b16 v[146:147], v250 offset:46080
    s_waitcnt lgkmcnt(10)
    v_mfma_f32_32x32x16_bf16 v[208:223], v[156:159], v[36:39], v[208:223]
    ds_read_b64_tr_b16 v[148:149], v251 offset:45056
    ds_read_b64_tr_b16 v[150:151], v251 offset:46080
    s_waitcnt lgkmcnt(10)
    v_mfma_f32_32x32x16_bf16 v[160:175], v[128:131], v[40:43], v[160:175]
    ds_read_b64_tr_b16 v[152:153], v252 offset:45056
    ds_read_b64_tr_b16 v[154:155], v252 offset:46080
    s_waitcnt lgkmcnt(10)
    v_mfma_f32_32x32x16_bf16 v[176:191], v[132:135], v[40:43], v[176:191]
    ds_read_b64_tr_b16 v[156:157], v253 offset:45056
    ds_read_b64_tr_b16 v[158:159], v253 offset:46080
    s_waitcnt lgkmcnt(10)
    v_mfma_f32_32x32x16_bf16 v[192:207], v[136:139], v[40:43], v[192:207]
    ds_read_b64_tr_b16 v[128:129], v250 offset:49152
    ds_read_b64_tr_b16 v[130:131], v250 offset:50176
    s_waitcnt lgkmcnt(10)
    v_mfma_f32_32x32x16_bf16 v[208:223], v[140:143], v[40:43], v[208:223]
    ds_read_b64_tr_b16 v[132:133], v251 offset:49152
    ds_read_b64_tr_b16 v[134:135], v251 offset:50176
    s_waitcnt lgkmcnt(10)
    v_mfma_f32_32x32x16_bf16 v[160:175], v[144:147], v[44:47], v[160:175]
    ds_read_b64_tr_b16 v[136:137], v252 offset:49152
    ds_read_b64_tr_b16 v[138:139], v252 offset:50176
    s_waitcnt lgkmcnt(10)
    v_mfma_f32_32x32x16_bf16 v[176:191], v[148:151], v[44:47], v[176:191]
    ds_read_b64_tr_b16 v[140:141], v253 offset:49152
    ds_read_b64_tr_b16 v[142:143], v253 offset:50176
    s_waitcnt lgkmcnt(10)
    v_mfma_f32_32x32x16_bf16 v[192:207], v[152:155], v[44:47], v[192:207]
    ds_read_b64_tr_b16 v[144:145], v250 offset:53248
    ds_read_b64_tr_b16 v[146:147], v250 offset:54272
    s_waitcnt lgkmcnt(10)
    v_mfma_f32_32x32x16_bf16 v[208:223], v[156:159], v[44:47], v[208:223]
    ds_read_b64_tr_b16 v[148:149], v251 offset:53248
    ds_read_b64_tr_b16 v[150:151], v251 offset:54272
    s_waitcnt lgkmcnt(10)
    v_mfma_f32_32x32x16_bf16 v[160:175], v[128:131], v[48:51], v[160:175]
    ds_read_b64_tr_b16 v[152:153], v252 offset:53248
    ds_read_b64_tr_b16 v[154:155], v252 offset:54272
    s_waitcnt lgkmcnt(10)
    v_mfma_f32_32x32x16_bf16 v[176:191], v[132:135], v[48:51], v[176:191]
    ds_read_b64_tr_b16 v[156:157], v253 offset:53248
    ds_read_b64_tr_b16 v[158:159], v253 offset:54272
    s_waitcnt lgkmcnt(10)
    v_mfma_f32_32x32x16_bf16 v[192:207], v[136:139], v[48:51], v[192:207]
    ds_read_b64_tr_b16 v[128:129], v250 offset:57344
    ds_read_b64_tr_b16 v[130:131], v250 offset:58368
    s_waitcnt lgkmcnt(10)
    v_mfma_f32_32x32x16_bf16 v[208:223], v[140:143], v[48:51], v[208:223]
    ds_read_b64_tr_b16 v[132:133], v251 offset:57344
    ds_read_b64_tr_b16 v[134:135], v251 offset:58368
    s_waitcnt lgkmcnt(10)
    v_mfma_f32_32x32x16_bf16 v[160:175], v[144:147], v[52:55], v[160:175]
    ds_read_b64_tr_b16 v[136:137], v252 offset:57344
    ds_read_b64_tr_b16 v[138:139], v252 offset:58368
    s_waitcnt lgkmcnt(10)
    v_mfma_f32_32x32x16_bf16 v[176:191], v[148:151], v[52:55], v[176:191]
    ds_read_b64_tr_b16 v[140:141], v253 offset:57344
    ds_read_b64_tr_b16 v[142:143], v253 offset:58368
    s_waitcnt lgkmcnt(10)
    v_mfma_f32_32x32x16_bf16 v[192:207], v[152:155], v[52:55], v[192:207]
    ds_read_b64_tr_b16 v[144:145], v250 offset:61440
    ds_read_b64_tr_b16 v[146:147], v250 offset:62464
    s_waitcnt lgkmcnt(10)
    v_mfma_f32_32x32x16_bf16 v[208:223], v[156:159], v[52:55], v[208:223]
    ds_read_b64_tr_b16 v[148:149], v251 offset:61440
    ds_read_b64_tr_b16 v[150:151], v251 offset:62464
    s_waitcnt lgkmcnt(10)
    v_mfma_f32_32x32x16_bf16 v[160:175], v[128:131], v[56:59], v[160:175]
    ds_read_b64_tr_b16 v[152:153], v252 offset:61440
    ds_read_b64_tr_b16 v[154:155], v252 offset:62464
    s_waitcnt lgkmcnt(10)
    v_mfma_f32_32x32x16_bf16 v[176:191], v[132:135], v[56:59], v[176:191]
    ds_read_b64_tr_b16 v[156:157], v253 offset:61440
    ds_read_b64_tr_b16 v[158:159], v253 offset:62464
    s_waitcnt lgkmcnt(10)
    v_mfma_f32_32x32x16_bf16 v[192:207], v[136:139], v[56:59], v[192:207]
    s_waitcnt lgkmcnt(8)
    v_mfma_f32_32x32x16_bf16 v[208:223], v[140:143], v[56:59], v[208:223]
    s_waitcnt lgkmcnt(6)
    v_mfma_f32_32x32x16_bf16 v[160:175], v[144:147], v[60:63], v[160:175]
    s_waitcnt lgkmcnt(4)
    v_mfma_f32_32x32x16_bf16 v[176:191], v[148:151], v[60:63], v[176:191]
    s_waitcnt lgkmcnt(2)
    v_mfma_f32_32x32x16_bf16 v[192:207], v[152:155], v[60:63], v[192:207]
    s_waitcnt lgkmcnt(0)
    v_mfma_f32_32x32x16_bf16 v[208:223], v[156:159], v[60:63], v[208:223]
    s_waitcnt vmcnt(12)
    s_barrier
    v_add_u32 v250, 0x10000, v250
    v_add_u32 v251, 0x10000, v251
    v_add_u32 v252, 0x10000, v252
    v_add_u32 v253, 0x10000, v253
    ds_read_b64_tr_b16 v[128:129], v250 offset:0
    ds_read_b64_tr_b16 v[130:131], v250 offset:1024
    ds_read_b64_tr_b16 v[132:133], v251 offset:0
    ds_read_b64_tr_b16 v[134:135], v251 offset:1024
    ds_read_b64_tr_b16 v[136:137], v252 offset:0
    ds_read_b64_tr_b16 v[138:139], v252 offset:1024
    ds_read_b64_tr_b16 v[140:141], v253 offset:0
    ds_read_b64_tr_b16 v[142:143], v253 offset:1024
    ds_read_b64_tr_b16 v[144:145], v250 offset:4096
    ds_read_b64_tr_b16 v[146:147], v250 offset:5120
    ds_read_b64_tr_b16 v[148:149], v251 offset:4096
    ds_read_b64_tr_b16 v[150:151], v251 offset:5120
    s_waitcnt lgkmcnt(10)
    v_mfma_f32_32x32x16_bf16 v[160:175], v[128:131], v[64:67], v[160:175]
    ds_read_b64_tr_b16 v[152:153], v252 offset:4096
    ds_read_b64_tr_b16 v[154:155], v252 offset:5120
    s_waitcnt lgkmcnt(10)
    v_mfma_f32_32x32x16_bf16 v[176:191], v[132:135], v[64:67], v[176:191]
    ds_read_b64_tr_b16 v[156:157], v253 offset:4096
    ds_read_b64_tr_b16 v[158:159], v253 offset:5120
    s_waitcnt lgkmcnt(10)
    v_mfma_f32_32x32x16_bf16 v[192:207], v[136:139], v[64:67], v[192:207]
    ds_read_b64_tr_b16 v[128:129], v250 offset:8192
    ds_read_b64_tr_b16 v[130:131], v250 offset:9216
    s_waitcnt lgkmcnt(10)
    v_mfma_f32_32x32x16_bf16 v[208:223], v[140:143], v[64:67], v[208:223]
    ds_read_b64_tr_b16 v[132:133], v251 offset:8192
    ds_read_b64_tr_b16 v[134:135], v251 offset:9216
    s_waitcnt lgkmcnt(10)
    v_mfma_f32_32x32x16_bf16 v[160:175], v[144:147], v[68:71], v[160:175]
    ds_read_b64_tr_b16 v[136:137], v252 offset:8192
    ds_read_b64_tr_b16 v[138:139], v252 offset:9216
    s_waitcnt lgkmcnt(10)
    v_mfma_f32_32x32x16_bf16 v[176:191], v[148:151], v[68:71], v[176:191]
    ds_read_b64_tr_b16 v[140:141], v253 offset:8192
    ds_read_b64_tr_b16 v[142:143], v253 offset:9216
    s_waitcnt lgkmcnt(10)
    v_mfma_f32_32x32x16_bf16 v[192:207], v[152:155], v[68:71], v[192:207]
    ds_read_b64_tr_b16 v[144:145], v250 offset:12288
    ds_read_b64_tr_b16 v[146:147], v250 offset:13312
    s_waitcnt lgkmcnt(10)
    v_mfma_f32_32x32x16_bf16 v[208:223], v[156:159], v[68:71], v[208:223]
    ds_read_b64_tr_b16 v[148:149], v251 offset:12288
    ds_read_b64_tr_b16 v[150:151], v251 offset:13312
    s_waitcnt lgkmcnt(10)
    v_mfma_f32_32x32x16_bf16 v[160:175], v[128:131], v[72:75], v[160:175]
    ds_read_b64_tr_b16 v[152:153], v252 offset:12288
    ds_read_b64_tr_b16 v[154:155], v252 offset:13312
    s_waitcnt lgkmcnt(10)
    v_mfma_f32_32x32x16_bf16 v[176:191], v[132:135], v[72:75], v[176:191]
    ds_read_b64_tr_b16 v[156:157], v253 offset:12288
    ds_read_b64_tr_b16 v[158:159], v253 offset:13312
    s_waitcnt lgkmcnt(10)
    v_mfma_f32_32x32x16_bf16 v[192:207], v[136:139], v[72:75], v[192:207]
    ds_read_b64_tr_b16 v[128:129], v250 offset:16384
    ds_read_b64_tr_b16 v[130:131], v250 offset:17408
    s_waitcnt lgkmcnt(10)
    v_mfma_f32_32x32x16_bf16 v[208:223], v[140:143], v[72:75], v[208:223]
    ds_read_b64_tr_b16 v[132:133], v251 offset:16384
    ds_read_b64_tr_b16 v[134:135], v251 offset:17408
    s_waitcnt lgkmcnt(10)
    v_mfma_f32_32x32x16_bf16 v[160:175], v[144:147], v[76:79], v[160:175]
    ds_read_b64_tr_b16 v[136:137], v252 offset:16384
    ds_read_b64_tr_b16 v[138:139], v252 offset:17408
    s_waitcnt lgkmcnt(10)
    v_mfma_f32_32x32x16_bf16 v[176:191], v[148:151], v[76:79], v[176:191]
    ds_read_b64_tr_b16 v[140:141], v253 offset:16384
    ds_read_b64_tr_b16 v[142:143], v253 offset:17408
    s_waitcnt lgkmcnt(10)
    v_mfma_f32_32x32x16_bf16 v[192:207], v[152:155], v[76:79], v[192:207]
    ds_read_b64_tr_b16 v[144:145], v250 offset:20480
    ds_read_b64_tr_b16 v[146:147], v250 offset:21504
    s_waitcnt lgkmcnt(10)
    v_mfma_f32_32x32x16_bf16 v[208:223], v[156:159], v[76:79], v[208:223]
    ds_read_b64_tr_b16 v[148:149], v251 offset:20480
    ds_read_b64_tr_b16 v[150:151], v251 offset:21504
    s_waitcnt lgkmcnt(10)
    v_mfma_f32_32x32x16_bf16 v[160:175], v[128:131], v[80:83], v[160:175]
    ds_read_b64_tr_b16 v[152:153], v252 offset:20480
    ds_read_b64_tr_b16 v[154:155], v252 offset:21504
    s_waitcnt lgkmcnt(10)
    v_mfma_f32_32x32x16_bf16 v[176:191], v[132:135], v[80:83], v[176:191]
    ds_read_b64_tr_b16 v[156:157], v253 offset:20480
    ds_read_b64_tr_b16 v[158:159], v253 offset:21504
    s_waitcnt lgkmcnt(10)
    v_mfma_f32_32x32x16_bf16 v[192:207], v[136:139], v[80:83], v[192:207]
    ds_read_b64_tr_b16 v[128:129], v250 offset:24576
    ds_read_b64_tr_b16 v[130:131], v250 offset:25600
    s_waitcnt lgkmcnt(10)
    v_mfma_f32_32x32x16_bf16 v[208:223], v[140:143], v[80:83], v[208:223]
    ds_read_b64_tr_b16 v[132:133], v251 offset:24576
    ds_read_b64_tr_b16 v[134:135], v251 offset:25600
    s_waitcnt lgkmcnt(10)
    v_mfma_f32_32x32x16_bf16 v[160:175], v[144:147], v[84:87], v[160:175]
    ds_read_b64_tr_b16 v[136:137], v252 offset:24576
    ds_read_b64_tr_b16 v[138:139], v252 offset:25600
    s_waitcnt lgkmcnt(10)
    v_mfma_f32_32x32x16_bf16 v[176:191], v[148:151], v[84:87], v[176:191]
    ds_read_b64_tr_b16 v[140:141], v253 offset:24576
    ds_read_b64_tr_b16 v[142:143], v253 offset:25600
    s_waitcnt lgkmcnt(10)
    v_mfma_f32_32x32x16_bf16 v[192:207], v[152:155], v[84:87], v[192:207]
    ds_read_b64_tr_b16 v[144:145], v250 offset:28672
    ds_read_b64_tr_b16 v[146:147], v250 offset:29696
    s_waitcnt lgkmcnt(10)
    v_mfma_f32_32x32x16_bf16 v[208:223], v[156:159], v[84:87], v[208:223]
    ds_read_b64_tr_b16 v[148:149], v251 offset:28672
    ds_read_b64_tr_b16 v[150:151], v251 offset:29696
    s_waitcnt lgkmcnt(10)
    v_mfma_f32_32x32x16_bf16 v[160:175], v[128:131], v[88:91], v[160:175]
    ds_read_b64_tr_b16 v[152:153], v252 offset:28672
    ds_read_b64_tr_b16 v[154:155], v252 offset:29696
    s_waitcnt lgkmcnt(10)
    v_mfma_f32_32x32x16_bf16 v[176:191], v[132:135], v[88:91], v[176:191]
    ds_read_b64_tr_b16 v[156:157], v253 offset:28672
    ds_read_b64_tr_b16 v[158:159], v253 offset:29696
    s_waitcnt lgkmcnt(10)
    v_mfma_f32_32x32x16_bf16 v[192:207], v[136:139], v[88:91], v[192:207]
    s_waitcnt lgkmcnt(8)
    v_mfma_f32_32x32x16_bf16 v[208:223], v[140:143], v[88:91], v[208:223]
    s_waitcnt lgkmcnt(6)
    v_mfma_f32_32x32x16_bf16 v[160:175], v[144:147], v[92:95], v[160:175]
    s_waitcnt lgkmcnt(4)
    v_mfma_f32_32x32x16_bf16 v[176:191], v[148:151], v[92:95], v[176:191]
    s_waitcnt lgkmcnt(2)
    v_mfma_f32_32x32x16_bf16 v[192:207], v[152:155], v[92:95], v[192:207]
    s_waitcnt lgkmcnt(0)
    v_mfma_f32_32x32x16_bf16 v[208:223], v[156:159], v[92:95], v[208:223]
    s_waitcnt vmcnt(4)
    s_barrier
    ds_read_b64_tr_b16 v[128:129], v250 offset:32768
    ds_read_b64_tr_b16 v[130:131], v250 offset:33792
    ds_read_b64_tr_b16 v[132:133], v251 offset:32768
    ds_read_b64_tr_b16 v[134:135], v251 offset:33792
    ds_read_b64_tr_b16 v[136:137], v252 offset:32768
    ds_read_b64_tr_b16 v[138:139], v252 offset:33792
    ds_read_b64_tr_b16 v[140:141], v253 offset:32768
    ds_read_b64_tr_b16 v[142:143], v253 offset:33792
    ds_read_b64_tr_b16 v[144:145], v250 offset:36864
    ds_read_b64_tr_b16 v[146:147], v250 offset:37888
    ds_read_b64_tr_b16 v[148:149], v251 offset:36864
    ds_read_b64_tr_b16 v[150:151], v251 offset:37888
    s_waitcnt lgkmcnt(10)
    v_mfma_f32_32x32x16_bf16 v[160:175], v[128:131], v[96:99], v[160:175]
    ds_read_b64_tr_b16 v[152:153], v252 offset:36864
    ds_read_b64_tr_b16 v[154:155], v252 offset:37888
    s_waitcnt lgkmcnt(10)
    v_mfma_f32_32x32x16_bf16 v[176:191], v[132:135], v[96:99], v[176:191]
    ds_read_b64_tr_b16 v[156:157], v253 offset:36864
    ds_read_b64_tr_b16 v[158:159], v253 offset:37888
    s_waitcnt lgkmcnt(10)
    v_mfma_f32_32x32x16_bf16 v[192:207], v[136:139], v[96:99], v[192:207]
    ds_read_b64_tr_b16 v[128:129], v250 offset:40960
    ds_read_b64_tr_b16 v[130:131], v250 offset:41984
    s_waitcnt lgkmcnt(10)
    v_mfma_f32_32x32x16_bf16 v[208:223], v[140:143], v[96:99], v[208:223]
    ds_read_b64_tr_b16 v[132:133], v251 offset:40960
    ds_read_b64_tr_b16 v[134:135], v251 offset:41984
    s_waitcnt lgkmcnt(10)
    v_mfma_f32_32x32x16_bf16 v[160:175], v[144:147], v[100:103], v[160:175]
    ds_read_b64_tr_b16 v[136:137], v252 offset:40960
    ds_read_b64_tr_b16 v[138:139], v252 offset:41984
    s_waitcnt lgkmcnt(10)
    v_mfma_f32_32x32x16_bf16 v[176:191], v[148:151], v[100:103], v[176:191]
    ds_read_b64_tr_b16 v[140:141], v253 offset:40960
    ds_read_b64_tr_b16 v[142:143], v253 offset:41984
    s_waitcnt lgkmcnt(10)
    v_mfma_f32_32x32x16_bf16 v[192:207], v[152:155], v[100:103], v[192:207]
    ds_read_b64_tr_b16 v[144:145], v250 offset:45056
    ds_read_b64_tr_b16 v[146:147], v250 offset:46080
    s_waitcnt lgkmcnt(10)
    v_mfma_f32_32x32x16_bf16 v[208:223], v[156:159], v[100:103], v[208:223]
    ds_read_b64_tr_b16 v[148:149], v251 offset:45056
    ds_read_b64_tr_b16 v[150:151], v251 offset:46080
    s_waitcnt lgkmcnt(10)
    v_mfma_f32_32x32x16_bf16 v[160:175], v[128:131], v[104:107], v[160:175]
    ds_read_b64_tr_b16 v[152:153], v252 offset:45056
    ds_read_b64_tr_b16 v[154:155], v252 offset:46080
    s_waitcnt lgkmcnt(10)
    v_mfma_f32_32x32x16_bf16 v[176:191], v[132:135], v[104:107], v[176:191]
    ds_read_b64_tr_b16 v[156:157], v253 offset:45056
    ds_read_b64_tr_b16 v[158:159], v253 offset:46080
    s_waitcnt lgkmcnt(10)
    v_mfma_f32_32x32x16_bf16 v[192:207], v[136:139], v[104:107], v[192:207]
    ds_read_b64_tr_b16 v[128:129], v250 offset:49152
    ds_read_b64_tr_b16 v[130:131], v250 offset:50176
    s_waitcnt lgkmcnt(10)
    v_mfma_f32_32x32x16_bf16 v[208:223], v[140:143], v[104:107], v[208:223]
    ds_read_b64_tr_b16 v[132:133], v251 offset:49152
    ds_read_b64_tr_b16 v[134:135], v251 offset:50176
    s_waitcnt lgkmcnt(10)
    v_mfma_f32_32x32x16_bf16 v[160:175], v[144:147], v[108:111], v[160:175]
    ds_read_b64_tr_b16 v[136:137], v252 offset:49152
    ds_read_b64_tr_b16 v[138:139], v252 offset:50176
    s_waitcnt lgkmcnt(10)
    v_mfma_f32_32x32x16_bf16 v[176:191], v[148:151], v[108:111], v[176:191]
    ds_read_b64_tr_b16 v[140:141], v253 offset:49152
    ds_read_b64_tr_b16 v[142:143], v253 offset:50176
    s_waitcnt lgkmcnt(10)
    v_mfma_f32_32x32x16_bf16 v[192:207], v[152:155], v[108:111], v[192:207]
    ds_read_b64_tr_b16 v[144:145], v250 offset:53248
    ds_read_b64_tr_b16 v[146:147], v250 offset:54272
    s_waitcnt lgkmcnt(10)
    v_mfma_f32_32x32x16_bf16 v[208:223], v[156:159], v[108:111], v[208:223]
    ds_read_b64_tr_b16 v[148:149], v251 offset:53248
    ds_read_b64_tr_b16 v[150:151], v251 offset:54272
    s_waitcnt lgkmcnt(10)
    v_mfma_f32_32x32x16_bf16 v[160:175], v[128:131], v[112:115], v[160:175]
    ds_read_b64_tr_b16 v[152:153], v252 offset:53248
    ds_read_b64_tr_b16 v[154:155], v252 offset:54272
    s_waitcnt lgkmcnt(10)
    v_mfma_f32_32x32x16_bf16 v[176:191], v[132:135], v[112:115], v[176:191]
    ds_read_b64_tr_b16 v[156:157], v253 offset:53248
    ds_read_b64_tr_b16 v[158:159], v253 offset:54272
    s_waitcnt lgkmcnt(10)
    v_mfma_f32_32x32x16_bf16 v[192:207], v[136:139], v[112:115], v[192:207]
    ds_read_b64_tr_b16 v[128:129], v250 offset:57344
    ds_read_b64_tr_b16 v[130:131], v250 offset:58368
    s_waitcnt lgkmcnt(10)
    v_mfma_f32_32x32x16_bf16 v[208:223], v[140:143], v[112:115], v[208:223]
    ds_read_b64_tr_b16 v[132:133], v251 offset:57344
    ds_read_b64_tr_b16 v[134:135], v251 offset:58368
    s_waitcnt lgkmcnt(10)
    v_mfma_f32_32x32x16_bf16 v[160:175], v[144:147], v[116:119], v[160:175]
    ds_read_b64_tr_b16 v[136:137], v252 offset:57344
    ds_read_b64_tr_b16 v[138:139], v252 offset:58368
    s_waitcnt lgkmcnt(10)
    v_mfma_f32_32x32x16_bf16 v[176:191], v[148:151], v[116:119], v[176:191]
    ds_read_b64_tr_b16 v[140:141], v253 offset:57344
    ds_read_b64_tr_b16 v[142:143], v253 offset:58368
    s_waitcnt lgkmcnt(10)
    v_mfma_f32_32x32x16_bf16 v[192:207], v[152:155], v[116:119], v[192:207]
    ds_read_b64_tr_b16 v[144:145], v250 offset:61440
    ds_read_b64_tr_b16 v[146:147], v250 offset:62464
    s_waitcnt lgkmcnt(10)
    v_mfma_f32_32x32x16_bf16 v[208:223], v[156:159], v[116:119], v[208:223]
    ds_read_b64_tr_b16 v[148:149], v251 offset:61440
    ds_read_b64_tr_b16 v[150:151], v251 offset:62464
    s_waitcnt lgkmcnt(10)
    v_mfma_f32_32x32x16_bf16 v[160:175], v[128:131], v[120:123], v[160:175]
    ds_read_b64_tr_b16 v[152:153], v252 offset:61440
    ds_read_b64_tr_b16 v[154:155], v252 offset:62464
    s_waitcnt lgkmcnt(10)
    v_mfma_f32_32x32x16_bf16 v[176:191], v[132:135], v[120:123], v[176:191]
    ds_read_b64_tr_b16 v[156:157], v253 offset:61440
    ds_read_b64_tr_b16 v[158:159], v253 offset:62464
    s_waitcnt lgkmcnt(10)
    v_mfma_f32_32x32x16_bf16 v[192:207], v[136:139], v[120:123], v[192:207]
    s_waitcnt lgkmcnt(8)
    v_mfma_f32_32x32x16_bf16 v[208:223], v[140:143], v[120:123], v[208:223]
    s_waitcnt lgkmcnt(6)
    v_mfma_f32_32x32x16_bf16 v[160:175], v[144:147], v[124:127], v[160:175]
    s_waitcnt lgkmcnt(4)
    v_mfma_f32_32x32x16_bf16 v[176:191], v[148:151], v[124:127], v[176:191]
    s_waitcnt lgkmcnt(2)
    v_mfma_f32_32x32x16_bf16 v[192:207], v[152:155], v[124:127], v[192:207]
    s_waitcnt lgkmcnt(0)
    v_mfma_f32_32x32x16_bf16 v[208:223], v[156:159], v[124:127], v[208:223]
    s_nop 15
    s_nop 3
    v_mul_f32 v160, s38, v160
    v_mul_f32 v161, s38, v161
    v_cvt_pk_bf16_f32 v128, v160, v161
    v_mul_f32 v162, s38, v162
    v_mul_f32 v163, s38, v163
    v_cvt_pk_bf16_f32 v129, v162, v163
    v_mul_f32 v164, s38, v164
    v_mul_f32 v165, s38, v165
    v_cvt_pk_bf16_f32 v130, v164, v165
    v_mul_f32 v166, s38, v166
    v_mul_f32 v167, s38, v167
    v_cvt_pk_bf16_f32 v131, v166, v167
    v_mul_f32 v168, s38, v168
    v_mul_f32 v169, s38, v169
    v_cvt_pk_bf16_f32 v132, v168, v169
    v_mul_f32 v170, s38, v170
    v_mul_f32 v171, s38, v171
    v_cvt_pk_bf16_f32 v133, v170, v171
    v_mul_f32 v172, s38, v172
    v_mul_f32 v173, s38, v173
    v_cvt_pk_bf16_f32 v134, v172, v173
    v_mul_f32 v174, s38, v174
    v_mul_f32 v175, s38, v175
    v_cvt_pk_bf16_f32 v135, v174, v175
    v_mul_f32 v176, s38, v176
    v_mul_f32 v177, s38, v177
    v_cvt_pk_bf16_f32 v136, v176, v177
    v_mul_f32 v178, s38, v178
    v_mul_f32 v179, s38, v179
    v_cvt_pk_bf16_f32 v137, v178, v179
    v_mul_f32 v180, s38, v180
    v_mul_f32 v181, s38, v181
    v_cvt_pk_bf16_f32 v138, v180, v181
    v_mul_f32 v182, s38, v182
    v_mul_f32 v183, s38, v183
    v_cvt_pk_bf16_f32 v139, v182, v183
    v_mul_f32 v184, s38, v184
    v_mul_f32 v185, s38, v185
    v_cvt_pk_bf16_f32 v140, v184, v185
    v_mul_f32 v186, s38, v186
    v_mul_f32 v187, s38, v187
    v_cvt_pk_bf16_f32 v141, v186, v187
    v_mul_f32 v188, s38, v188
    v_mul_f32 v189, s38, v189
    v_cvt_pk_bf16_f32 v142, v188, v189
    v_mul_f32 v190, s38, v190
    v_mul_f32 v191, s38, v191
    v_cvt_pk_bf16_f32 v143, v190, v191
    v_mul_f32 v192, s38, v192
    v_mul_f32 v193, s38, v193
    v_cvt_pk_bf16_f32 v144, v192, v193
    v_mul_f32 v194, s38, v194
    v_mul_f32 v195, s38, v195
    v_cvt_pk_bf16_f32 v145, v194, v195
    v_mul_f32 v196, s38, v196
    v_mul_f32 v197, s38, v197
    v_cvt_pk_bf16_f32 v146, v196, v197
    v_mul_f32 v198, s38, v198
    v_mul_f32 v199, s38, v199
    v_cvt_pk_bf16_f32 v147, v198, v199
    v_mul_f32 v200, s38, v200
    v_mul_f32 v201, s38, v201
    v_cvt_pk_bf16_f32 v148, v200, v201
    v_mul_f32 v202, s38, v202
    v_mul_f32 v203, s38, v203
    v_cvt_pk_bf16_f32 v149, v202, v203
    v_mul_f32 v204, s38, v204
    v_mul_f32 v205, s38, v205
    v_cvt_pk_bf16_f32 v150, v204, v205
    v_mul_f32 v206, s38, v206
    v_mul_f32 v207, s38, v207
    v_cvt_pk_bf16_f32 v151, v206, v207
    v_mul_f32 v208, s38, v208
    v_mul_f32 v209, s38, v209
    v_cvt_pk_bf16_f32 v152, v208, v209
    v_mul_f32 v210, s38, v210
    v_mul_f32 v211, s38, v211
    v_cvt_pk_bf16_f32 v153, v210, v211
    v_mul_f32 v212, s38, v212
    v_mul_f32 v213, s38, v213
    v_cvt_pk_bf16_f32 v154, v212, v213
    v_mul_f32 v214, s38, v214
    v_mul_f32 v215, s38, v215
    v_cvt_pk_bf16_f32 v155, v214, v215
    v_mul_f32 v216, s38, v216
    v_mul_f32 v217, s38, v217
    v_cvt_pk_bf16_f32 v156, v216, v217
    v_mul_f32 v218, s38, v218
    v_mul_f32 v219, s38, v219
    v_cvt_pk_bf16_f32 v157, v218, v219
    v_mul_f32 v220, s38, v220
    v_mul_f32 v221, s38, v221
    v_cvt_pk_bf16_f32 v158, v220, v221
    v_mul_f32 v222, s38, v222
    v_mul_f32 v223, s38, v223
    v_cvt_pk_bf16_f32 v159, v222, v223
    v_lshrrev_b32 v243, 5, v248
    v_and_b32 v244, 31, v248
    v_and_b32 v245, 15, v248
    v_xor_b32 v245, v245, v243
    v_lshlrev_b32 v244, 8, v244
    v_add_u32 v244, 0x18000, v244
    v_xor_b32 v246, 0, v245
    v_lshl_add_u32 v224, v246, 4, v244
    v_xor_b32 v246, 2, v245
    v_lshl_add_u32 v225, v246, 4, v244
    v_xor_b32 v246, 4, v245
    v_lshl_add_u32 v226, v246, 4, v244
    v_xor_b32 v246, 6, v245
    v_lshl_add_u32 v227, v246, 4, v244
    v_xor_b32 v246, 8, v245
    v_lshl_add_u32 v228, v246, 4, v244
    v_xor_b32 v246, 10, v245
    v_lshl_add_u32 v229, v246, 4, v244
    v_xor_b32 v246, 12, v245
    v_lshl_add_u32 v230, v246, 4, v244
    v_xor_b32 v246, 14, v245
    v_lshl_add_u32 v231, v246, 4, v244
    s_waitcnt vmcnt(0)
    s_barrier
    s_add_u32 m0, s42, 0
    s_nop 0
    buffer_load_dwordx4 v236, s[12:15], s40 offen lds
    buffer_load_dwordx4 v237, s[12:15], s40 offen offset:1024 lds
    s_add_u32 s40, s40, 16384
    s_add_u32 m0, s42, 16384
    s_nop 0
    buffer_load_dwordx4 v236, s[12:15], s40 offen lds
    v_lshrrev_b32 v243, 4, v248
    v_and_b32 v244, 7, v248
    v_lshlrev_b32 v240, 6, v243
    v_lshl_add_u32 v240, v244, 3, v240
    v_bfe_u32 v245, v248, 3, 1
    v_lshl_add_u32 v240, v245, 13, v240
    v_add_u32 v255, 0x1000, v240
    buffer_load_dwordx2 v[208:209], v240, s[92:95], s100 offen offset:0
    buffer_load_dwordx2 v[210:211], v240, s[92:95], s100 offen offset:1024
    buffer_load_dwordx2 v[212:213], v240, s[92:95], s100 offen offset:2048
    buffer_load_dwordx2 v[214:215], v240, s[92:95], s100 offen offset:3072
    buffer_load_dwordx2 v[216:217], v255, s[92:95], s100 offen offset:0
    buffer_load_dwordx2 v[218:219], v255, s[92:95], s100 offen offset:1024
    buffer_load_dwordx2 v[220:221], v255, s[92:95], s100 offen offset:2048
    buffer_load_dwordx2 v[222:223], v255, s[92:95], s100 offen offset:3072
    s_mov_b32 s37, 376832
    v_mul_lo_u32 v239, v243, s37
    v_and_b32 v246, 4, v244
    v_and_b32 v247, 1, v244
    v_lshl_add_u32 v246, v247, 1, v246
    v_bfe_u32 v247, v244, 1, 1
    v_add_u32 v246, v246, v247
    v_lshl_add_u32 v239, v246, 6, v239
    v_lshl_add_u32 v239, v245, 9, v239
    v_mov_b32 v0, 0
    v_mov_b32 v1, 0
    v_mov_b32 v2, 0
    v_mov_b32 v3, 0
    v_mov_b32 v4, 0
    v_mov_b32 v5, 0
    v_mov_b32 v6, 0
    v_mov_b32 v7, 0
    v_mov_b32 v8, 0
    v_mov_b32 v9, 0
    v_mov_b32 v10, 0
    v_mov_b32 v11, 0
    v_mov_b32 v12, 0
    v_mov_b32 v13, 0
    v_mov_b32 v14, 0
    v_mov_b32 v15, 0
    v_mov_b32 v16, 0
    v_mov_b32 v17, 0
    v_mov_b32 v18, 0
    v_mov_b32 v19, 0
    v_mov_b32 v20, 0
    v_mov_b32 v21, 0
    v_mov_b32 v22, 0
    v_mov_b32 v23, 0
    v_mov_b32 v24, 0
    v_mov_b32 v25, 0
    v_mov_b32 v26, 0
    v_mov_b32 v27, 0
    v_mov_b32 v28, 0
    v_mov_b32 v29, 0
    v_mov_b32 v30, 0
    v_mov_b32 v31, 0
    v_mov_b32 v32, 0
    v_mov_b32 v33, 0
    v_mov_b32 v34, 0
    v_mov_b32 v35, 0
    v_mov_b32 v36, 0
    v_mov_b32 v37, 0
    v_mov_b32 v38, 0
    v_mov_b32 v39, 0
    v_mov_b32 v40, 0
    v_mov_b32 v41, 0
    v_mov_b32 v42, 0
    v_mov_b32 v43, 0
    v_mov_b32 v44, 0
    v_mov_b32 v45, 0
    v_mov_b32 v46, 0
    v_mov_b32 v47, 0
    v_mov_b32 v48, 0
    v_mov_b32 v49, 0
    v_mov_b32 v50, 0
    v_mov_b32 v51, 0
    v_mov_b32 v52, 0
    v_mov_b32 v53, 0
    v_mov_b32 v54, 0
    v_mov_b32 v55, 0
    v_mov_b32 v56, 0
    v_mov_b32 v57, 0
    v_mov_b32 v58, 0
    v_mov_b32 v59, 0
    v_mov_b32 v60, 0
    v_mov_b32 v61, 0
    v_mov_b32 v62, 0
    v_mov_b32 v63, 0
    v_mov_b32 v192, 0
    v_mov_b32 v193, 0
    v_mov_b32 v194, 0
    v_mov_b32 v195, 0
    v_mov_b32 v196, 0
    v_mov_b32 v197, 0
    v_mov_b32 v198, 0
    v_mov_b32 v199, 0
    v_mov_b32 v200, 0
    v_mov_b32 v201, 0
    v_mov_b32 v202, 0
    v_mov_b32 v203, 0
    v_mov_b32 v204, 0
    v_mov_b32 v205, 0
    v_mov_b32 v206, 0
    v_mov_b32 v207, 0
    v_mov_b32 v241, 0
    v_mov_b32 v242, 0
    ds_read_b128 v[160:163], v224 offset:32768
    ds_read_b128 v[164:167], v225 offset:32768
    ds_read_b128 v[168:171], v226 offset:32768
    ds_read_b128 v[172:175], v227 offset:32768
    ds_read_b128 v[176:179], v228 offset:32768
    s_waitcnt lgkmcnt(4)
    v_mfma_f32_32x32x16_bf16 v[64:79], v[160:163], v[128:131], 0
    ds_read_b128 v[180:183], v229 offset:32768
    s_waitcnt lgkmcnt(4)
    v_mfma_f32_32x32x16_bf16 v[64:79], v[164:167], v[132:135], v[64:79]
    ds_read_b128 v[184:187], v230 offset:32768
    s_waitcnt lgkmcnt(4)
    v_mfma_f32_32x32x16_bf16 v[64:79], v[168:171], v[136:139], v[64:79]
    ds_read_b128 v[188:191], v231 offset:32768
    s_waitcnt lgkmcnt(4)
    v_mfma_f32_32x32x16_bf16 v[64:79], v[172:175], v[140:143], v[64:79]
    ds_read_b128 v[160:163], v224 offset:40960
    s_waitcnt lgkmcnt(4)
    v_mfma_f32_32x32x16_bf16 v[64:79], v[176:179], v[144:147], v[64:79]
    ds_read_b128 v[164:167], v225 offset:40960
    s_waitcnt lgkmcnt(4)
    v_mfma_f32_32x32x16_bf16 v[64:79], v[180:183], v[148:151], v[64:79]
    ds_read_b128 v[168:171], v226 offset:40960
    s_waitcnt lgkmcnt(4)
    v_mfma_f32_32x32x16_bf16 v[64:79], v[184:187], v[152:155], v[64:79]
    ds_read_b128 v[172:175], v227 offset:40960
    s_waitcnt lgkmcnt(4)
    v_mfma_f32_32x32x16_bf16 v[64:79], v[188:191], v[156:159], v[64:79]
    ds_read_b128 v[176:179], v228 offset:40960
    s_waitcnt lgkmcnt(4)
    v_mfma_f32_32x32x16_bf16 v[80:95], v[160:163], v[128:131], 0
    ds_read_b128 v[180:183], v229 offset:40960
    s_waitcnt lgkmcnt(4)
    v_mfma_f32_32x32x16_bf16 v[80:95], v[164:167], v[132:135], v[80:95]
    ds_read_b128 v[184:187], v230 offset:40960
    s_waitcnt lgkmcnt(4)
    v_mfma_f32_32x32x16_bf16 v[80:95], v[168:171], v[136:139], v[80:95]
    ds_read_b128 v[188:191], v231 offset:40960
    s_waitcnt lgkmcnt(4)
    v_mfma_f32_32x32x16_bf16 v[80:95], v[172:175], v[140:143], v[80:95]
    s_waitcnt lgkmcnt(3)
    v_mfma_f32_32x32x16_bf16 v[80:95], v[176:179], v[144:147], v[80:95]
    s_waitcnt lgkmcnt(2)
    v_mfma_f32_32x32x16_bf16 v[80:95], v[180:183], v[148:151], v[80:95]
    s_waitcnt lgkmcnt(1)
    v_mfma_f32_32x32x16_bf16 v[80:95], v[184:187], v[152:155], v[80:95]
    s_waitcnt lgkmcnt(0)
    v_mfma_f32_32x32x16_bf16 v[80:95], v[188:191], v[156:159], v[80:95]
    s_nop 15
    s_nop 3
    v_max3_f32 v243, v64, v65, v66
    v_max3_f32 v244, v80, v81, v82
    v_max3_f32 v243, v243, v67, v68
    v_max3_f32 v244, v244, v83, v84
    v_max3_f32 v243, v243, v69, v70
    v_max3_f32 v244, v244, v85, v86
    v_max3_f32 v243, v243, v71, v72
    v_max3_f32 v244, v244, v87, v88
    v_max3_f32 v243, v243, v73, v74
    v_max3_f32 v244, v244, v89, v90
    v_max3_f32 v243, v243, v75, v76
    v_max3_f32 v244, v244, v91, v92
    v_max3_f32 v243, v243, v77, v78
    v_max3_f32 v244, v244, v93, v94
    v_max3_f32 v243, v243, v79, v95
    v_max_f32 v243, v243, v244
    v_mov_b32 v244, v243
    s_nop 1
    v_permlane32_swap_b32 v243, v244
    s_nop 1
    v_max_f32 v243, v243, v244
    v_sub_f32 v245, 0, v243
    v_exp_f32 v245, v245
    v_sub_f32 v192, v192, v243
    v_mov_b32 v193, v192
    v_mov_b32 v194, v192
    v_mov_b32 v195, v192
    v_mov_b32 v196, v192
    v_mov_b32 v197, v192
    v_mov_b32 v198, v192
    v_mov_b32 v199, v192
    v_mov_b32 v200, v192
    v_mov_b32 v201, v192
    v_mov_b32 v202, v192
    v_mov_b32 v203, v192
    v_mov_b32 v204, v192
    v_mov_b32 v205, v192
    v_mov_b32 v206, v192
    v_mov_b32 v207, v192
    v_sub_f32 v64, v64, v243
    v_sub_f32 v65, v65, v243
    v_sub_f32 v66, v66, v243
    v_sub_f32 v67, v67, v243
    v_sub_f32 v68, v68, v243
    v_sub_f32 v69, v69, v243
    v_sub_f32 v70, v70, v243
    v_sub_f32 v71, v71, v243
    v_sub_f32 v72, v72, v243
    v_sub_f32 v73, v73, v243
    v_sub_f32 v74, v74, v243
    v_sub_f32 v75, v75, v243
    v_sub_f32 v76, v76, v243
    v_sub_f32 v77, v77, v243
    v_sub_f32 v78, v78, v243
    v_sub_f32 v79, v79, v243
    v_sub_f32 v80, v80, v243
    v_sub_f32 v81, v81, v243
    v_sub_f32 v82, v82, v243
    v_sub_f32 v83, v83, v243
    v_sub_f32 v84, v84, v243
    v_sub_f32 v85, v85, v243
    v_sub_f32 v86, v86, v243
    v_sub_f32 v87, v87, v243
    v_sub_f32 v88, v88, v243
    v_sub_f32 v89, v89, v243
    v_sub_f32 v90, v90, v243
    v_sub_f32 v91, v91, v243
    v_sub_f32 v92, v92, v243
    v_sub_f32 v93, v93, v243
    v_sub_f32 v94, v94, v243
    v_sub_f32 v95, v95, v243
    s_nop 1
    ds_read_b128 v[160:163], v224 offset:49152
    ds_read_b128 v[164:167], v225 offset:49152
    ds_read_b128 v[168:171], v226 offset:49152
    ds_read_b128 v[172:175], v227 offset:49152
    s_mov_b32 s39, 0
L_attn_loop:
    ds_read_b128 v[176:179], v228 offset:49152
    s_waitcnt lgkmcnt(4)
    v_mfma_f32_32x32x16_bf16 v[96:111], v[160:163], v[128:131], v[192:207]
    v_exp_f32 v64, v64
    v_exp_f32 v65, v65
    ds_read_b128 v[180:183], v229 offset:49152
    s_waitcnt lgkmcnt(4)
    v_mfma_f32_32x32x16_bf16 v[96:111], v[164:167], v[132:135], v[96:111]
    v_exp_f32 v66, v66
    buffer_load_dwordx4 v237, s[12:15], s40 offen offset:1024 lds
    s_add_u32 s40, s40, 16384
    ds_read_b128 v[184:187], v230 offset:49152
    s_waitcnt lgkmcnt(4)
    v_mfma_f32_32x32x16_bf16 v[96:111], v[168:171], v[136:139], v[96:111]
    v_exp_f32 v67, v67
    v_add_f32 v241, v241, v64
    v_add_f32 v242, v242, v65
    v_add_f32 v241, v241, v66
    v_add_f32 v242, v242, v67
    ds_read_b128 v[188:191], v231 offset:49152
    s_waitcnt lgkmcnt(4)
    v_mfma_f32_32x32x16_bf16 v[96:111], v[172:175], v[140:143], v[96:111]
    v_cvt_pk_bf16_f32 v64, v64, v65
    v_cvt_pk_bf16_f32 v65, v66, v67
    v_exp_f32 v68, v68
    ds_read_b128 v[160:163], v224 offset:57344
    s_waitcnt lgkmcnt(4)
    v_mfma_f32_32x32x16_bf16 v[96:111], v[176:179], v[144:147], v[96:111]
    v_exp_f32 v69, v69
    v_exp_f32 v70, v70
    ds_read_b128 v[164:167], v225 offset:57344
    s_waitcnt lgkmcnt(4)
    v_mfma_f32_32x32x16_bf16 v[96:111], v[180:183], v[148:151], v[96:111]
    v_exp_f32 v71, v71
    v_add_f32 v241, v241, v68
    ds_read_b128 v[168:171], v226 offset:57344
    s_waitcnt lgkmcnt(4)
    v_mfma_f32_32x32x16_bf16 v[96:111], v[184:187], v[152:155], v[96:111]
    v_add_f32 v242, v242, v69
    v_add_f32 v241, v241, v70
    v_add_f32 v242, v242, v71
    v_cvt_pk_bf16_f32 v66, v68, v69
    v_cvt_pk_bf16_f32 v67, v70, v71
    ds_read_b128 v[172:175], v227 offset:57344
    s_waitcnt lgkmcnt(4)
    v_mfma_f32_32x32x16_bf16 v[96:111], v[188:191], v[156:159], v[96:111]
    v_exp_f32 v72, v72
    v_exp_f32 v73, v73
    s_add_u32 m0, s43, 32768
    s_nop 0
    buffer_load_dwordx4 v238, s[16:19], s41 offen lds
    ds_read_b128 v[176:179], v228 offset:57344
    s_waitcnt lgkmcnt(4)
    v_mfma_f32_32x32x16_bf16 v[112:127], v[160:163], v[128:131], v[192:207]
    v_exp_f32 v74, v74
    v_exp_f32 v75, v75
    ds_read_b128 v[180:183], v229 offset:57344
    s_waitcnt lgkmcnt(4)
    v_mfma_f32_32x32x16_bf16 v[112:127], v[164:167], v[132:135], v[112:127]
    v_add_f32 v241, v241, v72
    v_add_f32 v242, v242, v73
    v_add_f32 v241, v241, v74
    v_add_f32 v242, v242, v75
    v_cvt_pk_bf16_f32 v68, v72, v73
    ds_read_b128 v[184:187], v230 offset:57344
    s_waitcnt lgkmcnt(4)
    v_mfma_f32_32x32x16_bf16 v[112:127], v[168:171], v[136:139], v[112:127]
    v_cvt_pk_bf16_f32 v69, v74, v75
    v_exp_f32 v76, v76
    ds_read_b128 v[188:191], v231 offset:57344
    s_waitcnt lgkmcnt(4)
    v_mfma_f32_32x32x16_bf16 v[112:127], v[172:175], v[140:143], v[112:127]
    v_exp_f32 v77, v77
    v_exp_f32 v78, v78
    ds_read_b64_tr_b16 v[160:161], v232 offset:0
    ds_read_b64_tr_b16 v[162:163], v232 offset:2048
    s_waitcnt lgkmcnt(5)
    v_mfma_f32_32x32x16_bf16 v[112:127], v[176:179], v[144:147], v[112:127]
    v_exp_f32 v79, v79
    v_add_f32 v241, v241, v76
    v_add_f32 v242, v242, v77
    v_add_f32 v241, v241, v78
    ds_read_b64_tr_b16 v[164:165], v233 offset:0
    ds_read_b64_tr_b16 v[166:167], v233 offset:2048
    s_waitcnt lgkmcnt(6)
    v_mfma_f32_32x32x16_bf16 v[112:127], v[180:183], v[148:151], v[112:127]
    v_add_f32 v242, v242, v79
    v_cvt_pk_bf16_f32 v70, v76, v77
    v_cvt_pk_bf16_f32 v71, v78, v79
    v_exp_f32 v80, v80
    buffer_load_dwordx4 v238, s[16:19], s41 offen offset:1024 lds
    s_add_u32 s41, s41, 16384
    ds_read_b64_tr_b16 v[168:169], v234 offset:0
    ds_read_b64_tr_b16 v[170:171], v234 offset:2048
    s_waitcnt lgkmcnt(7)
    v_mfma_f32_32x32x16_bf16 v[112:127], v[184:187], v[152:155], v[112:127]
    v_exp_f32 v81, v81
    ds_read_b64_tr_b16 v[172:173], v235 offset:0
    ds_read_b64_tr_b16 v[174:175], v235 offset:2048
    s_waitcnt lgkmcnt(8)
    v_mfma_f32_32x32x16_bf16 v[112:127], v[188:191], v[156:159], v[112:127]
    v_exp_f32 v82, v82
    v_exp_f32 v83, v83
    ds_read_b64_tr_b16 v[176:177], v232 offset:4096
    ds_read_b64_tr_b16 v[178:179], v232 offset:6144
    s_waitcnt lgkmcnt(8)
    v_mfma_f32_32x32x16_bf16 v[0:15], v[160:163], v[64:67], v[0:15]
    v_add_f32 v241, v241, v80
    v_add_f32 v242, v242, v81
    v_add_f32 v241, v241, v82
    v_add_f32 v242, v242, v83
    v_cvt_pk_bf16_f32 v72, v80, v81
    v_cvt_pk_bf16_f32 v73, v82, v83
    ds_read_b64_tr_b16 v[180:181], v233 offset:4096
    ds_read_b64_tr_b16 v[182:183], v233 offset:6144
    s_waitcnt lgkmcnt(8)
    v_mfma_f32_32x32x16_bf16 v[16:31], v[164:167], v[64:67], v[16:31]
    v_exp_f32 v84, v84
    v_exp_f32 v85, v85
    ds_read_b64_tr_b16 v[184:185], v234 offset:4096
    ds_read_b64_tr_b16 v[186:187], v234 offset:6144
    s_waitcnt lgkmcnt(8)
    v_mfma_f32_32x32x16_bf16 v[32:47], v[168:171], v[64:67], v[32:47]
    v_exp_f32 v86, v86
    ds_read_b64_tr_b16 v[188:189], v235 offset:4096
    ds_read_b64_tr_b16 v[190:191], v235 offset:6144
    s_waitcnt lgkmcnt(8)
    v_mfma_f32_32x32x16_bf16 v[48:63], v[172:175], v[64:67], v[48:63]
    v_exp_f32 v87, v87
    v_add_f32 v241, v241, v84
    v_add_f32 v242, v242, v85
    v_add_f32 v241, v241, v86
    v_add_f32 v242, v242, v87
    ds_read_b64_tr_b16 v[160:161], v232 offset:8192
    ds_read_b64_tr_b16 v[162:163], v232 offset:10240
    s_waitcnt lgkmcnt(8)
    v_mfma_f32_32x32x16_bf16 v[0:15], v[176:179], v[68:71], v[0:15]
    v_cvt_pk_bf16_f32 v74, v84, v85
    v_cvt_pk_bf16_f32 v75, v86, v87
    v_exp_f32 v88, v88
    ds_read_b64_tr_b16 v[164:165], v233 offset:8192
    ds_read_b64_tr_b16 v[166:167], v233 offset:10240
    s_waitcnt lgkmcnt(8)
    v_mfma_f32_32x32x16_bf16 v[16:31], v[180:183], v[68:71], v[16:31]
    v_exp_f32 v89, v89
    v_exp_f32 v90, v90
    ds_read_b64_tr_b16 v[168:169], v234 offset:8192
    ds_read_b64_tr_b16 v[170:171], v234 offset:10240
    s_waitcnt lgkmcnt(8)
    v_mfma_f32_32x32x16_bf16 v[32:47], v[184:187], v[68:71], v[32:47]
    v_exp_f32 v91, v91
    v_add_f32 v241, v241, v88
    v_add_f32 v242, v242, v89
    ds_read_b64_tr_b16 v[172:173], v235 offset:8192
    ds_read_b64_tr_b16 v[174:175], v235 offset:10240
    s_waitcnt lgkmcnt(8)
    v_mfma_f32_32x32x16_bf16 v[48:63], v[188:191], v[68:71], v[48:63]
    v_add_f32 v241, v241, v90
    v_add_f32 v242, v242, v91
    v_cvt_pk_bf16_f32 v76, v88, v89
    v_cvt_pk_bf16_f32 v77, v90, v91
    v_exp_f32 v92, v92
    ds_read_b64_tr_b16 v[176:177], v232 offset:12288
    ds_read_b64_tr_b16 v[178:179], v232 offset:14336
    s_waitcnt lgkmcnt(8)
    v_mfma_f32_32x32x16_bf16 v[0:15], v[160:163], v[72:75], v[0:15]
    v_exp_f32 v93, v93
    ds_read_b64_tr_b16 v[180:181], v233 offset:12288
    ds_read_b64_tr_b16 v[182:183], v233 offset:14336
    s_waitcnt lgkmcnt(8)
    v_mfma_f32_32x32x16_bf16 v[16:31], v[164:167], v[72:75], v[16:31]
    v_exp_f32 v94, v94
    v_exp_f32 v95, v95
    ds_read_b64_tr_b16 v[184:185], v234 offset:12288
    ds_read_b64_tr_b16 v[186:187], v234 offset:14336
    s_waitcnt lgkmcnt(8)
    v_mfma_f32_32x32x16_bf16 v[32:47], v[168:171], v[72:75], v[32:47]
    v_add_f32 v241, v241, v92
    v_add_f32 v242, v242, v93
    v_add_f32 v241, v241, v94
    v_add_f32 v242, v242, v95
    v_cvt_pk_bf16_f32 v78, v92, v93
    v_cvt_pk_bf16_f32 v79, v94, v95
    ds_read_b64_tr_b16 v[188:189], v235 offset:12288
    ds_read_b64_tr_b16 v[190:191], v235 offset:14336
    s_waitcnt lgkmcnt(8)
    v_mfma_f32_32x32x16_bf16 v[48:63], v[172:175], v[72:75], v[48:63]
    v_max3_f32 v243, v96, v97, v98
    v_max3_f32 v244, v112, v113, v114
    v_max3_f32 v243, v243, v99, v100
    v_max3_f32 v244, v244, v115, v116
    s_waitcnt vmcnt(4)
    s_barrier
    ds_read_b128 v[160:163], v224 offset:0
    s_waitcnt lgkmcnt(7)
    v_mfma_f32_32x32x16_bf16 v[0:15], v[176:179], v[76:79], v[0:15]
    v_max3_f32 v243, v243, v101, v102
    v_max3_f32 v244, v244, v117, v118
    v_max3_f32 v243, v243, v103, v104
    v_max3_f32 v244, v244, v119, v120
    ds_read_b128 v[164:167], v225 offset:0
    s_waitcnt lgkmcnt(6)
    v_mfma_f32_32x32x16_bf16 v[16:31], v[180:183], v[76:79], v[16:31]
    v_max3_f32 v243, v243, v105, v106
    v_max3_f32 v244, v244, v121, v122
    v_max3_f32 v243, v243, v107, v108
    v_max3_f32 v244, v244, v123, v124
    s_add_u32 m0, s42, 32768
    s_nop 0
    buffer_load_dwordx4 v236, s[12:15], s40 offen lds
    ds_read_b128 v[168:171], v226 offset:0
    s_waitcnt lgkmcnt(5)
    v_mfma_f32_32x32x16_bf16 v[32:47], v[184:187], v[76:79], v[32:47]
    v_max3_f32 v243, v243, v109, v110
    v_max3_f32 v244, v244, v125, v126
    v_max3_f32 v243, v243, v111, v127
    v_max_f32 v243, v243, v244
    ds_read_b128 v[172:175], v227 offset:0
    s_waitcnt lgkmcnt(4)
    v_mfma_f32_32x32x16_bf16 v[48:63], v[188:191], v[76:79], v[48:63]
    v_mov_b32 v244, v243
    s_nop 1
    v_permlane32_swap_b32 v243, v244
    s_nop 1
    v_max_f32 v243, v243, v244
    v_cmp_lt_f32 vcc, 0x42400000, v243
    s_cbranch_vccnz L_resc_0
L_resc_ret_0:
    ds_read_b128 v[176:179], v228 offset:0
    s_waitcnt lgkmcnt(4)
    v_mfma_f32_32x32x16_bf16 v[64:79], v[160:163], v[128:131], v[192:207]
    v_exp_f32 v96, v96
    v_exp_f32 v97, v97
    ds_read_b128 v[180:183], v229 offset:0
    s_waitcnt lgkmcnt(4)
    v_mfma_f32_32x32x16_bf16 v[64:79], v[164:167], v[132:135], v[64:79]
    v_exp_f32 v98, v98
    buffer_load_dwordx4 v237, s[12:15], s40 offen offset:1024 lds
    s_add_u32 s40, s40, 16384
    ds_read_b128 v[184:187], v230 offset:0
    s_waitcnt lgkmcnt(4)
    v_mfma_f32_32x32x16_bf16 v[64:79], v[168:171], v[136:139], v[64:79]
    v_exp_f32 v99, v99
    v_add_f32 v241, v241, v96
    v_add_f32 v242, v242, v97
    v_add_f32 v241, v241, v98
    v_add_f32 v242, v242, v99
    ds_read_b128 v[188:191], v231 offset:0
    s_waitcnt lgkmcnt(4)
    v_mfma_f32_32x32x16_bf16 v[64:79], v[172:175], v[140:143], v[64:79]
    v_cvt_pk_bf16_f32 v96, v96, v97
    v_cvt_pk_bf16_f32 v97, v98, v99
    v_exp_f32 v100, v100
    ds_read_b128 v[160:163], v224 offset:8192
    s_waitcnt lgkmcnt(4)
    v_mfma_f32_32x32x16_bf16 v[64:79], v[176:179], v[144:147], v[64:79]
    v_exp_f32 v101, v101
    v_exp_f32 v102, v102
    ds_read_b128 v[164:167], v225 offset:8192
    s_waitcnt lgkmcnt(4)
    v_mfma_f32_32x32x16_bf16 v[64:79], v[180:183], v[148:151], v[64:79]
    v_exp_f32 v103, v103
    v_add_f32 v241, v241, v100
    ds_read_b128 v[168:171], v226 offset:8192
    s_waitcnt lgkmcnt(4)
    v_mfma_f32_32x32x16_bf16 v[64:79], v[184:187], v[152:155], v[64:79]
    v_add_f32 v242, v242, v101
    v_add_f32 v241, v241, v102
    v_add_f32 v242, v242, v103
    v_cvt_pk_bf16_f32 v98, v100, v101
    v_cvt_pk_bf16_f32 v99, v102, v103
    ds_read_b128 v[172:175], v227 offset:8192
    s_waitcnt lgkmcnt(4)
    v_mfma_f32_32x32x16_bf16 v[64:79], v[188:191], v[156:159], v[64:79]
    v_exp_f32 v104, v104
    v_exp_f32 v105, v105
    s_add_u32 m0, s43, 49152
    s_nop 0
    buffer_load_dwordx4 v238, s[16:19], s41 offen lds
    ds_read_b128 v[176:179], v228 offset:8192
    s_waitcnt lgkmcnt(4)
    v_mfma_f32_32x32x16_bf16 v[80:95], v[160:163], v[128:131], v[192:207]
    v_exp_f32 v106, v106
    v_exp_f32 v107, v107
    ds_read_b128 v[180:183], v229 offset:8192
    s_waitcnt lgkmcnt(4)
    v_mfma_f32_32x32x16_bf16 v[80:95], v[164:167], v[132:135], v[80:95]
    v_add_f32 v241, v241, v104
    v_add_f32 v242, v242, v105
    v_add_f32 v241, v241, v106
    v_add_f32 v242, v242, v107
    v_cvt_pk_bf16_f32 v100, v104, v105
    ds_read_b128 v[184:187], v230 offset:8192
    s_waitcnt lgkmcnt(4)
    v_mfma_f32_32x32x16_bf16 v[80:95], v[168:171], v[136:139], v[80:95]
    v_cvt_pk_bf16_f32 v101, v106, v107
    v_exp_f32 v108, v108
    ds_read_b128 v[188:191], v231 offset:8192
    s_waitcnt lgkmcnt(4)
    v_mfma_f32_32x32x16_bf16 v[80:95], v[172:175], v[140:143], v[80:95]
    v_exp_f32 v109, v109
    v_exp_f32 v110, v110
    ds_read_b64_tr_b16 v[160:161], v232 offset:16384
    ds_read_b64_tr_b16 v[162:163], v232 offset:18432
    s_waitcnt lgkmcnt(5)
    v_mfma_f32_32x32x16_bf16 v[80:95], v[176:179], v[144:147], v[80:95]
    v_exp_f32 v111, v111
    v_add_f32 v241, v241, v108
    v_add_f32 v242, v242, v109
    v_add_f32 v241, v241, v110
    ds_read_b64_tr_b16 v[164:165], v233 offset:16384
    ds_read_b64_tr_b16 v[166:167], v233 offset:18432
    s_waitcnt lgkmcnt(6)
    v_mfma_f32_32x32x16_bf16 v[80:95], v[180:183], v[148:151], v[80:95]
    v_add_f32 v242, v242, v111
    v_cvt_pk_bf16_f32 v102, v108, v109
    v_cvt_pk_bf16_f32 v103, v110, v111
    v_exp_f32 v112, v112
    buffer_load_dwordx4 v238, s[16:19], s41 offen offset:1024 lds
    s_add_u32 s41, s41, 16384
    ds_read_b64_tr_b16 v[168:169], v234 offset:16384
    ds_read_b64_tr_b16 v[170:171], v234 offset:18432
    s_waitcnt lgkmcnt(7)
    v_mfma_f32_32x32x16_bf16 v[80:95], v[184:187], v[152:155], v[80:95]
    v_exp_f32 v113, v113
    ds_read_b64_tr_b16 v[172:173], v235 offset:16384
    ds_read_b64_tr_b16 v[174:175], v235 offset:18432
    s_waitcnt lgkmcnt(8)
    v_mfma_f32_32x32x16_bf16 v[80:95], v[188:191], v[156:159], v[80:95]
    v_exp_f32 v114, v114
    v_exp_f32 v115, v115
    ds_read_b64_tr_b16 v[176:177], v232 offset:20480
    ds_read_b64_tr_b16 v[178:179], v232 offset:22528
    s_waitcnt lgkmcnt(8)
    v_mfma_f32_32x32x16_bf16 v[0:15], v[160:163], v[96:99], v[0:15]
    v_add_f32 v241, v241, v112
    v_add_f32 v242, v242, v113
    v_add_f32 v241, v241, v114
    v_add_f32 v242, v242, v115
    v_cvt_pk_bf16_f32 v104, v112, v113
    v_cvt_pk_bf16_f32 v105, v114, v115
    ds_read_b64_tr_b16 v[180:181], v233 offset:20480
    ds_read_b64_tr_b16 v[182:183], v233 offset:22528
    s_waitcnt lgkmcnt(8)
    v_mfma_f32_32x32x16_bf16 v[16:31], v[164:167], v[96:99], v[16:31]
    v_exp_f32 v116, v116
    v_exp_f32 v117, v117
    ds_read_b64_tr_b16 v[184:185], v234 offset:20480
    ds_read_b64_tr_b16 v[186:187], v234 offset:22528
    s_waitcnt lgkmcnt(8)
    v_mfma_f32_32x32x16_bf16 v[32:47], v[168:171], v[96:99], v[32:47]
    v_exp_f32 v118, v118
    ds_read_b64_tr_b16 v[188:189], v235 offset:20480
    ds_read_b64_tr_b16 v[190:191], v235 offset:22528
    s_waitcnt lgkmcnt(8)
    v_mfma_f32_32x32x16_bf16 v[48:63], v[172:175], v[96:99], v[48:63]
    v_exp_f32 v119, v119
    v_add_f32 v241, v241, v116
    v_add_f32 v242, v242, v117
    v_add_f32 v241, v241, v118
    v_add_f32 v242, v242, v119
    ds_read_b64_tr_b16 v[160:161], v232 offset:24576
    ds_read_b64_tr_b16 v[162:163], v232 offset:26624
    s_waitcnt lgkmcnt(8)
    v_mfma_f32_32x32x16_bf16 v[0:15], v[176:179], v[100:103], v[0:15]
    v_cvt_pk_bf16_f32 v106, v116, v117
    v_cvt_pk_bf16_f32 v107, v118, v119
    v_exp_f32 v120, v120
    ds_read_b64_tr_b16 v[164:165], v233 offset:24576
    ds_read_b64_tr_b16 v[166:167], v233 offset:26624
    s_waitcnt lgkmcnt(8)
    v_mfma_f32_32x32x16_bf16 v[16:31], v[180:183], v[100:103], v[16:31]
    v_exp_f32 v121, v121
    v_exp_f32 v122, v122
    ds_read_b64_tr_b16 v[168:169], v234 offset:24576
    ds_read_b64_tr_b16 v[170:171], v234 offset:26624
    s_waitcnt lgkmcnt(8)
    v_mfma_f32_32x32x16_bf16 v[32:47], v[184:187], v[100:103], v[32:47]
    v_exp_f32 v123, v123
    v_add_f32 v241, v241, v120
    v_add_f32 v242, v242, v121
    ds_read_b64_tr_b16 v[172:173], v235 offset:24576
    ds_read_b64_tr_b16 v[174:175], v235 offset:26624
    s_waitcnt lgkmcnt(8)
    v_mfma_f32_32x32x16_bf16 v[48:63], v[188:191], v[100:103], v[48:63]
    v_add_f32 v241, v241, v122
    v_add_f32 v242, v242, v123
    v_cvt_pk_bf16_f32 v108, v120, v121
    v_cvt_pk_bf16_f32 v109, v122, v123
    v_exp_f32 v124, v124
    ds_read_b64_tr_b16 v[176:177], v232 offset:28672
    ds_read_b64_tr_b16 v[178:179], v232 offset:30720
    s_waitcnt lgkmcnt(8)
    v_mfma_f32_32x32x16_bf16 v[0:15], v[160:163], v[104:107], v[0:15]
    v_exp_f32 v125, v125
    ds_read_b64_tr_b16 v[180:181], v233 offset:28672
    ds_read_b64_tr_b16 v[182:183], v233 offset:30720
    s_waitcnt lgkmcnt(8)
    v_mfma_f32_32x32x16_bf16 v[16:31], v[164:167], v[104:107], v[16:31]
    v_exp_f32 v126, v126
    v_exp_f32 v127, v127
    ds_read_b64_tr_b16 v[184:185], v234 offset:28672
    ds_read_b64_tr_b16 v[186:187], v234 offset:30720
    s_waitcnt lgkmcnt(8)
    v_mfma_f32_32x32x16_bf16 v[32:47], v[168:171], v[104:107], v[32:47]
    v_add_f32 v241, v241, v124
    v_add_f32 v242, v242, v125
    v_add_f32 v241, v241, v126
    v_add_f32 v242, v242, v127
    v_cvt_pk_bf16_f32 v110, v124, v125
    v_cvt_pk_bf16_f32 v111, v126, v127
    ds_read_b64_tr_b16 v[188:189], v235 offset:28672
    ds_read_b64_tr_b16 v[190:191], v235 offset:30720
    s_waitcnt lgkmcnt(8)
    v_mfma_f32_32x32x16_bf16 v[48:63], v[172:175], v[104:107], v[48:63]
    v_max3_f32 v243, v64, v65, v66
    v_max3_f32 v244, v80, v81, v82
    v_max3_f32 v243, v243, v67, v68
    v_max3_f32 v244, v244, v83, v84
    s_waitcnt vmcnt(4)
    s_barrier
    s_cmp_lg_u32 s39, 0
    s_cbranch_scc1 L_wp_skip
    v_perm_b32 v250, v210, v208, s90
    v_perm_b32 v251, v214, v212, s90
    v_perm_b32 v252, v218, v216, s90
    v_perm_b32 v253, v222, v220, s90
    buffer_store_dwordx4 v[250:253], v239, s[96:99], s101 offen offset:0
    s_nop 2
    v_perm_b32 v250, v210, v208, s91
    v_perm_b32 v251, v214, v212, s91
    v_perm_b32 v252, v218, v216, s91
    v_perm_b32 v253, v222, v220, s91
    buffer_store_dwordx4 v[250:253], v239, s[96:99], s101 offen offset:16
    s_nop 2
    v_perm_b32 v250, v211, v209, s90
    v_perm_b32 v251, v215, v213, s90
    v_perm_b32 v252, v219, v217, s90
    v_perm_b32 v253, v223, v221, s90
    buffer_store_dwordx4 v[250:253], v239, s[96:99], s101 offen offset:32
    s_nop 2
    v_perm_b32 v250, v211, v209, s91
    v_perm_b32 v251, v215, v213, s91
    v_perm_b32 v252, v219, v217, s91
    v_perm_b32 v253, v223, v221, s91
    buffer_store_dwordx4 v[250:253], v239, s[96:99], s101 offen offset:48
    s_nop 2
L_wp_skip:
    ds_read_b128 v[160:163], v224 offset:16384
    s_waitcnt lgkmcnt(7)
    v_mfma_f32_32x32x16_bf16 v[0:15], v[176:179], v[108:111], v[0:15]
    v_max3_f32 v243, v243, v69, v70
    v_max3_f32 v244, v244, v85, v86
    v_max3_f32 v243, v243, v71, v72
    v_max3_f32 v244, v244, v87, v88
    ds_read_b128 v[164:167], v225 offset:16384
    s_waitcnt lgkmcnt(6)
    v_mfma_f32_32x32x16_bf16 v[16:31], v[180:183], v[108:111], v[16:31]
    v_max3_f32 v243, v243, v73, v74
    v_max3_f32 v244, v244, v89, v90
    v_max3_f32 v243, v243, v75, v76
    v_max3_f32 v244, v244, v91, v92
    s_add_u32 m0, s42, 49152
    s_nop 0
    buffer_load_dwordx4 v236, s[12:15], s40 offen lds
    ds_read_b128 v[168:171], v226 offset:16384
    s_waitcnt lgkmcnt(5)
    v_mfma_f32_32x32x16_bf16 v[32:47], v[184:187], v[108:111], v[32:47]
    v_max3_f32 v243, v243, v77, v78
    v_max3_f32 v244, v244, v93, v94
    v_max3_f32 v243, v243, v79, v95
    v_max_f32 v243, v243, v244
    ds_read_b128 v[172:175], v227 offset:16384
    s_waitcnt lgkmcnt(4)
    v_mfma_f32_32x32x16_bf16 v[48:63], v[188:191], v[108:111], v[48:63]
    v_mov_b32 v244, v243
    s_nop 1
    v_permlane32_swap_b32 v243, v244
    s_nop 1
    v_max_f32 v243, v243, v244
    v_cmp_lt_f32 vcc, 0x42400000, v243
    s_cbranch_vccnz L_resc_1
L_resc_ret_1:
    ds_read_b128 v[176:179], v228 offset:16384
    s_waitcnt lgkmcnt(4)
    v_mfma_f32_32x32x16_bf16 v[96:111], v[160:163], v[128:131], v[192:207]
    v_exp_f32 v64, v64
    v_exp_f32 v65, v65
    ds_read_b128 v[180:183], v229 offset:16384
    s_waitcnt lgkmcnt(4)
    v_mfma_f32_32x32x16_bf16 v[96:111], v[164:167], v[132:135], v[96:111]
    v_exp_f32 v66, v66
    buffer_load_dwordx4 v237, s[12:15], s40 offen offset:1024 lds
    s_add_u32 s40, s40, 16384
    ds_read_b128 v[184:187], v230 offset:16384
    s_waitcnt lgkmcnt(4)
    v_mfma_f32_32x32x16_bf16 v[96:111], v[168:171], v[136:139], v[96:111]
    v_exp_f32 v67, v67
    v_add_f32 v241, v241, v64
    v_add_f32 v242, v242, v65
    v_add_f32 v241, v241, v66
    v_add_f32 v242, v242, v67
    ds_read_b128 v[188:191], v231 offset:16384
    s_waitcnt lgkmcnt(4)
    v_mfma_f32_32x32x16_bf16 v[96:111], v[172:175], v[140:143], v[96:111]
    v_cvt_pk_bf16_f32 v64, v64, v65
    v_cvt_pk_bf16_f32 v65, v66, v67
    v_exp_f32 v68, v68
    ds_read_b128 v[160:163], v224 offset:24576
    s_waitcnt lgkmcnt(4)
    v_mfma_f32_32x32x16_bf16 v[96:111], v[176:179], v[144:147], v[96:111]
    v_exp_f32 v69, v69
    v_exp_f32 v70, v70
    ds_read_b128 v[164:167], v225 offset:24576
    s_waitcnt lgkmcnt(4)
    v_mfma_f32_32x32x16_bf16 v[96:111], v[180:183], v[148:151], v[96:111]
    v_exp_f32 v71, v71
    v_add_f32 v241, v241, v68
    ds_read_b128 v[168:171], v226 offset:24576
    s_waitcnt lgkmcnt(4)
    v_mfma_f32_32x32x16_bf16 v[96:111], v[184:187], v[152:155], v[96:111]
    v_add_f32 v242, v242, v69
    v_add_f32 v241, v241, v70
    v_add_f32 v242, v242, v71
    v_cvt_pk_bf16_f32 v66, v68, v69
    v_cvt_pk_bf16_f32 v67, v70, v71
    ds_read_b128 v[172:175], v227 offset:24576
    s_waitcnt lgkmcnt(4)
    v_mfma_f32_32x32x16_bf16 v[96:111], v[188:191], v[156:159], v[96:111]
    v_exp_f32 v72, v72
    v_exp_f32 v73, v73
    s_add_u32 m0, s43, 0
    s_nop 0
    buffer_load_dwordx4 v238, s[16:19], s41 offen lds
    ds_read_b128 v[176:179], v228 offset:24576
    s_waitcnt lgkmcnt(4)
    v_mfma_f32_32x32x16_bf16 v[112:127], v[160:163], v[128:131], v[192:207]
    v_exp_f32 v74, v74
    v_exp_f32 v75, v75
    ds_read_b128 v[180:183], v229 offset:24576
    s_waitcnt lgkmcnt(4)
    v_mfma_f32_32x32x16_bf16 v[112:127], v[164:167], v[132:135], v[112:127]
    v_add_f32 v241, v241, v72
    v_add_f32 v242, v242, v73
    v_add_f32 v241, v241, v74
    v_add_f32 v242, v242, v75
    v_cvt_pk_bf16_f32 v68, v72, v73
    ds_read_b128 v[184:187], v230 offset:24576
    s_waitcnt lgkmcnt(4)
    v_mfma_f32_32x32x16_bf16 v[112:127], v[168:171], v[136:139], v[112:127]
    v_cvt_pk_bf16_f32 v69, v74, v75
    v_exp_f32 v76, v76
    ds_read_b128 v[188:191], v231 offset:24576
    s_waitcnt lgkmcnt(4)
    v_mfma_f32_32x32x16_bf16 v[112:127], v[172:175], v[140:143], v[112:127]
    v_exp_f32 v77, v77
    v_exp_f32 v78, v78
    ds_read_b64_tr_b16 v[160:161], v232 offset:32768
    ds_read_b64_tr_b16 v[162:163], v232 offset:34816
    s_waitcnt lgkmcnt(5)
    v_mfma_f32_32x32x16_bf16 v[112:127], v[176:179], v[144:147], v[112:127]
    v_exp_f32 v79, v79
    v_add_f32 v241, v241, v76
    v_add_f32 v242, v242, v77
    v_add_f32 v241, v241, v78
    ds_read_b64_tr_b16 v[164:165], v233 offset:32768
    ds_read_b64_tr_b16 v[166:167], v233 offset:34816
    s_waitcnt lgkmcnt(6)
    v_mfma_f32_32x32x16_bf16 v[112:127], v[180:183], v[148:151], v[112:127]
    v_add_f32 v242, v242, v79
    v_cvt_pk_bf16_f32 v70, v76, v77
    v_cvt_pk_bf16_f32 v71, v78, v79
    v_exp_f32 v80, v80
    buffer_load_dwordx4 v238, s[16:19], s41 offen offset:1024 lds
    s_add_u32 s41, s41, 16384
    ds_read_b64_tr_b16 v[168:169], v234 offset:32768
    ds_read_b64_tr_b16 v[170:171], v234 offset:34816
    s_waitcnt lgkmcnt(7)
    v_mfma_f32_32x32x16_bf16 v[112:127], v[184:187], v[152:155], v[112:127]
    v_exp_f32 v81, v81
    ds_read_b64_tr_b16 v[172:173], v235 offset:32768
    ds_read_b64_tr_b16 v[174:175], v235 offset:34816
    s_waitcnt lgkmcnt(8)
    v_mfma_f32_32x32x16_bf16 v[112:127], v[188:191], v[156:159], v[112:127]
    v_exp_f32 v82, v82
    v_exp_f32 v83, v83
    ds_read_b64_tr_b16 v[176:177], v232 offset:36864
    ds_read_b64_tr_b16 v[178:179], v232 offset:38912
    s_waitcnt lgkmcnt(8)
    v_mfma_f32_32x32x16_bf16 v[0:15], v[160:163], v[64:67], v[0:15]
    v_add_f32 v241, v241, v80
    v_add_f32 v242, v242, v81
    v_add_f32 v241, v241, v82
    v_add_f32 v242, v242, v83
    v_cvt_pk_bf16_f32 v72, v80, v81
    v_cvt_pk_bf16_f32 v73, v82, v83
    ds_read_b64_tr_b16 v[180:181], v233 offset:36864
    ds_read_b64_tr_b16 v[182:183], v233 offset:38912
    s_waitcnt lgkmcnt(8)
    v_mfma_f32_32x32x16_bf16 v[16:31], v[164:167], v[64:67], v[16:31]
    v_exp_f32 v84, v84
    v_exp_f32 v85, v85
    ds_read_b64_tr_b16 v[184:185], v234 offset:36864
    ds_read_b64_tr_b16 v[186:187], v234 offset:38912
    s_waitcnt lgkmcnt(8)
    v_mfma_f32_32x32x16_bf16 v[32:47], v[168:171], v[64:67], v[32:47]
    v_exp_f32 v86, v86
    ds_read_b64_tr_b16 v[188:189], v235 offset:36864
    ds_read_b64_tr_b16 v[190:191], v235 offset:38912
    s_waitcnt lgkmcnt(8)
    v_mfma_f32_32x32x16_bf16 v[48:63], v[172:175], v[64:67], v[48:63]
    v_exp_f32 v87, v87
    v_add_f32 v241, v241, v84
    v_add_f32 v242, v242, v85
    v_add_f32 v241, v241, v86
    v_add_f32 v242, v242, v87
    ds_read_b64_tr_b16 v[160:161], v232 offset:40960
    ds_read_b64_tr_b16 v[162:163], v232 offset:43008
    s_waitcnt lgkmcnt(8)
    v_mfma_f32_32x32x16_bf16 v[0:15], v[176:179], v[68:71], v[0:15]
    v_cvt_pk_bf16_f32 v74, v84, v85
    v_cvt_pk_bf16_f32 v75, v86, v87
    v_exp_f32 v88, v88
    ds_read_b64_tr_b16 v[164:165], v233 offset:40960
    ds_read_b64_tr_b16 v[166:167], v233 offset:43008
    s_waitcnt lgkmcnt(8)
    v_mfma_f32_32x32x16_bf16 v[16:31], v[180:183], v[68:71], v[16:31]
    v_exp_f32 v89, v89
    v_exp_f32 v90, v90
    ds_read_b64_tr_b16 v[168:169], v234 offset:40960
    ds_read_b64_tr_b16 v[170:171], v234 offset:43008
    s_waitcnt lgkmcnt(8)
    v_mfma_f32_32x32x16_bf16 v[32:47], v[184:187], v[68:71], v[32:47]
    v_exp_f32 v91, v91
    v_add_f32 v241, v241, v88
    v_add_f32 v242, v242, v89
    ds_read_b64_tr_b16 v[172:173], v235 offset:40960
    ds_read_b64_tr_b16 v[174:175], v235 offset:43008
    s_waitcnt lgkmcnt(8)
    v_mfma_f32_32x32x16_bf16 v[48:63], v[188:191], v[68:71], v[48:63]
    v_add_f32 v241, v241, v90
    v_add_f32 v242, v242, v91
    v_cvt_pk_bf16_f32 v76, v88, v89
    v_cvt_pk_bf16_f32 v77, v90, v91
    v_exp_f32 v92, v92
    ds_read_b64_tr_b16 v[176:177], v232 offset:45056
    ds_read_b64_tr_b16 v[178:179], v232 offset:47104
    s_waitcnt lgkmcnt(8)
    v_mfma_f32_32x32x16_bf16 v[0:15], v[160:163], v[72:75], v[0:15]
    v_exp_f32 v93, v93
    ds_read_b64_tr_b16 v[180:181], v233 offset:45056
    ds_read_b64_tr_b16 v[182:183], v233 offset:47104
    s_waitcnt lgkmcnt(8)
    v_mfma_f32_32x32x16_bf16 v[16:31], v[164:167], v[72:75], v[16:31]
    v_exp_f32 v94, v94
    v_exp_f32 v95, v95
    ds_read_b64_tr_b16 v[184:185], v234 offset:45056
    ds_read_b64_tr_b16 v[186:187], v234 offset:47104
    s_waitcnt lgkmcnt(8)
    v_mfma_f32_32x32x16_bf16 v[32:47], v[168:171], v[72:75], v[32:47]
    v_add_f32 v241, v241, v92
    v_add_f32 v242, v242, v93
    v_add_f32 v241, v241, v94
    v_add_f32 v242, v242, v95
    v_cvt_pk_bf16_f32 v78, v92, v93
    v_cvt_pk_bf16_f32 v79, v94, v95
    ds_read_b64_tr_b16 v[188:189], v235 offset:45056
    ds_read_b64_tr_b16 v[190:191], v235 offset:47104
    s_waitcnt lgkmcnt(8)
    v_mfma_f32_32x32x16_bf16 v[48:63], v[172:175], v[72:75], v[48:63]
    v_max3_f32 v243, v96, v97, v98
    v_max3_f32 v244, v112, v113, v114
    v_max3_f32 v243, v243, v99, v100
    v_max3_f32 v244, v244, v115, v116
    s_waitcnt vmcnt(4)
    s_barrier
    ds_read_b128 v[160:163], v224 offset:32768
    s_waitcnt lgkmcnt(7)
    v_mfma_f32_32x32x16_bf16 v[0:15], v[176:179], v[76:79], v[0:15]
    v_max3_f32 v243, v243, v101, v102
    v_max3_f32 v244, v244, v117, v118
    v_max3_f32 v243, v243, v103, v104
    v_max3_f32 v244, v244, v119, v120
    ds_read_b128 v[164:167], v225 offset:32768
    s_waitcnt lgkmcnt(6)
    v_mfma_f32_32x32x16_bf16 v[16:31], v[180:183], v[76:79], v[16:31]
    v_max3_f32 v243, v243, v105, v106
    v_max3_f32 v244, v244, v121, v122
    v_max3_f32 v243, v243, v107, v108
    v_max3_f32 v244, v244, v123, v124
    s_add_u32 m0, s42, 0
    s_nop 0
    buffer_load_dwordx4 v236, s[12:15], s40 offen lds
    ds_read_b128 v[168:171], v226 offset:32768
    s_waitcnt lgkmcnt(5)
    v_mfma_f32_32x32x16_bf16 v[32:47], v[184:187], v[76:79], v[32:47]
    v_max3_f32 v243, v243, v109, v110
    v_max3_f32 v244, v244, v125, v126
    v_max3_f32 v243, v243, v111, v127
    v_max_f32 v243, v243, v244
    ds_read_b128 v[172:175], v227 offset:32768
    s_waitcnt lgkmcnt(4)
    v_mfma_f32_32x32x16_bf16 v[48:63], v[188:191], v[76:79], v[48:63]
    v_mov_b32 v244, v243
    s_nop 1
    v_permlane32_swap_b32 v243, v244
    s_nop 1
    v_max_f32 v243, v243, v244
    v_cmp_lt_f32 vcc, 0x42400000, v243
    s_cbranch_vccnz L_resc_2
L_resc_ret_2:
    s_cmp_eq_u32 s39, 28
    s_cbranch_scc1 L_attn_tail
    ds_read_b128 v[176:179], v228 offset:32768
    s_waitcnt lgkmcnt(4)
    v_mfma_f32_32x32x16_bf16 v[64:79], v[160:163], v[128:131], v[192:207]
    v_exp_f32 v96, v96
    v_exp_f32 v97, v97
    ds_read_b128 v[180:183], v229 offset:32768
    s_waitcnt lgkmcnt(4)
    v_mfma_f32_32x32x16_bf16 v[64:79], v[164:167], v[132:135], v[64:79]
    v_exp_f32 v98, v98
    buffer_load_dwordx4 v237, s[12:15], s40 offen offset:1024 lds
    s_add_u32 s40, s40, 16384
    ds_read_b128 v[184:187], v230 offset:32768
    s_waitcnt lgkmcnt(4)
    v_mfma_f32_32x32x16_bf16 v[64:79], v[168:171], v[136:139], v[64:79]
    v_exp_f32 v99, v99
    v_add_f32 v241, v241, v96
    v_add_f32 v242, v242, v97
    v_add_f32 v241, v241, v98
    v_add_f32 v242, v242, v99
    ds_read_b128 v[188:191], v231 offset:32768
    s_waitcnt lgkmcnt(4)
    v_mfma_f32_32x32x16_bf16 v[64:79], v[172:175], v[140:143], v[64:79]
    v_cvt_pk_bf16_f32 v96, v96, v97
    v_cvt_pk_bf16_f32 v97, v98, v99
    v_exp_f32 v100, v100
    ds_read_b128 v[160:163], v224 offset:40960
    s_waitcnt lgkmcnt(4)
    v_mfma_f32_32x32x16_bf16 v[64:79], v[176:179], v[144:147], v[64:79]
    v_exp_f32 v101, v101
    v_exp_f32 v102, v102
    ds_read_b128 v[164:167], v225 offset:40960
    s_waitcnt lgkmcnt(4)
    v_mfma_f32_32x32x16_bf16 v[64:79], v[180:183], v[148:151], v[64:79]
    v_exp_f32 v103, v103
    v_add_f32 v241, v241, v100
    ds_read_b128 v[168:171], v226 offset:40960
    s_waitcnt lgkmcnt(4)
    v_mfma_f32_32x32x16_bf16 v[64:79], v[184:187], v[152:155], v[64:79]
    v_add_f32 v242, v242, v101
    v_add_f32 v241, v241, v102
    v_add_f32 v242, v242, v103
    v_cvt_pk_bf16_f32 v98, v100, v101
    v_cvt_pk_bf16_f32 v99, v102, v103
    ds_read_b128 v[172:175], v227 offset:40960
    s_waitcnt lgkmcnt(4)
    v_mfma_f32_32x32x16_bf16 v[64:79], v[188:191], v[156:159], v[64:79]
    v_exp_f32 v104, v104
    v_exp_f32 v105, v105
    s_add_u32 m0, s43, 16384
    s_nop 0
    buffer_load_dwordx4 v238, s[16:19], s41 offen lds
    ds_read_b128 v[176:179], v228 offset:40960
    s_waitcnt lgkmcnt(4)
    v_mfma_f32_32x32x16_bf16 v[80:95], v[160:163], v[128:131], v[192:207]
    v_exp_f32 v106, v106
    v_exp_f32 v107, v107
    ds_read_b128 v[180:183], v229 offset:40960
    s_waitcnt lgkmcnt(4)
    v_mfma_f32_32x32x16_bf16 v[80:95], v[164:167], v[132:135], v[80:95]
    v_add_f32 v241, v241, v104
    v_add_f32 v242, v242, v105
    v_add_f32 v241, v241, v106
    v_add_f32 v242, v242, v107
    v_cvt_pk_bf16_f32 v100, v104, v105
    ds_read_b128 v[184:187], v230 offset:40960
    s_waitcnt lgkmcnt(4)
    v_mfma_f32_32x32x16_bf16 v[80:95], v[168:171], v[136:139], v[80:95]
    v_cvt_pk_bf16_f32 v101, v106, v107
    v_exp_f32 v108, v108
    ds_read_b128 v[188:191], v231 offset:40960
    s_waitcnt lgkmcnt(4)
    v_mfma_f32_32x32x16_bf16 v[80:95], v[172:175], v[140:143], v[80:95]
    v_exp_f32 v109, v109
    v_exp_f32 v110, v110
    ds_read_b64_tr_b16 v[160:161], v232 offset:49152
    ds_read_b64_tr_b16 v[162:163], v232 offset:51200
    s_waitcnt lgkmcnt(5)
    v_mfma_f32_32x32x16_bf16 v[80:95], v[176:179], v[144:147], v[80:95]
    v_exp_f32 v111, v111
    v_add_f32 v241, v241, v108
    v_add_f32 v242, v242, v109
    v_add_f32 v241, v241, v110
    ds_read_b64_tr_b16 v[164:165], v233 offset:49152
    ds_read_b64_tr_b16 v[166:167], v233 offset:51200
    s_waitcnt lgkmcnt(6)
    v_mfma_f32_32x32x16_bf16 v[80:95], v[180:183], v[148:151], v[80:95]
    v_add_f32 v242, v242, v111
    v_cvt_pk_bf16_f32 v102, v108, v109
    v_cvt_pk_bf16_f32 v103, v110, v111
    v_exp_f32 v112, v112
    buffer_load_dwordx4 v238, s[16:19], s41 offen offset:1024 lds
    s_add_u32 s41, s41, 16384
    ds_read_b64_tr_b16 v[168:169], v234 offset:49152
    ds_read_b64_tr_b16 v[170:171], v234 offset:51200
    s_waitcnt lgkmcnt(7)
    v_mfma_f32_32x32x16_bf16 v[80:95], v[184:187], v[152:155], v[80:95]
    v_exp_f32 v113, v113
    ds_read_b64_tr_b16 v[172:173], v235 offset:49152
    ds_read_b64_tr_b16 v[174:175], v235 offset:51200
    s_waitcnt lgkmcnt(8)
    v_mfma_f32_32x32x16_bf16 v[80:95], v[188:191], v[156:159], v[80:95]
    v_exp_f32 v114, v114
    v_exp_f32 v115, v115
    ds_read_b64_tr_b16 v[176:177], v232 offset:53248
    ds_read_b64_tr_b16 v[178:179], v232 offset:55296
    s_waitcnt lgkmcnt(8)
    v_mfma_f32_32x32x16_bf16 v[0:15], v[160:163], v[96:99], v[0:15]
    v_add_f32 v241, v241, v112
    v_add_f32 v242, v242, v113
    v_add_f32 v241, v241, v114
    v_add_f32 v242, v242, v115
    v_cvt_pk_bf16_f32 v104, v112, v113
    v_cvt_pk_bf16_f32 v105, v114, v115
    ds_read_b64_tr_b16 v[180:181], v233 offset:53248
    ds_read_b64_tr_b16 v[182:183], v233 offset:55296
    s_waitcnt lgkmcnt(8)
    v_mfma_f32_32x32x16_bf16 v[16:31], v[164:167], v[96:99], v[16:31]
    v_exp_f32 v116, v116
    v_exp_f32 v117, v117
    ds_read_b64_tr_b16 v[184:185], v234 offset:53248
    ds_read_b64_tr_b16 v[186:187], v234 offset:55296
    s_waitcnt lgkmcnt(8)
    v_mfma_f32_32x32x16_bf16 v[32:47], v[168:171], v[96:99], v[32:47]
    v_exp_f32 v118, v118
    ds_read_b64_tr_b16 v[188:189], v235 offset:53248
    ds_read_b64_tr_b16 v[190:191], v235 offset:55296
    s_waitcnt lgkmcnt(8)
    v_mfma_f32_32x32x16_bf16 v[48:63], v[172:175], v[96:99], v[48:63]
    v_exp_f32 v119, v119
    v_add_f32 v241, v241, v116
    v_add_f32 v242, v242, v117
    v_add_f32 v241, v241, v118
    v_add_f32 v242, v242, v119
    ds_read_b64_tr_b16 v[160:161], v232 offset:57344
    ds_read_b64_tr_b16 v[162:163], v232 offset:59392
    s_waitcnt lgkmcnt(8)
    v_mfma_f32_32x32x16_bf16 v[0:15], v[176:179], v[100:103], v[0:15]
    v_cvt_pk_bf16_f32 v106, v116, v117
    v_cvt_pk_bf16_f32 v107, v118, v119
    v_exp_f32 v120, v120
    ds_read_b64_tr_b16 v[164:165], v233 offset:57344
    ds_read_b64_tr_b16 v[166:167], v233 offset:59392
    s_waitcnt lgkmcnt(8)
    v_mfma_f32_32x32x16_bf16 v[16:31], v[180:183], v[100:103], v[16:31]
    v_exp_f32 v121, v121
    v_exp_f32 v122, v122
    ds_read_b64_tr_b16 v[168:169], v234 offset:57344
    ds_read_b64_tr_b16 v[170:171], v234 offset:59392
    s_waitcnt lgkmcnt(8)
    v_mfma_f32_32x32x16_bf16 v[32:47], v[184:187], v[100:103], v[32:47]
    v_exp_f32 v123, v123
    v_add_f32 v241, v241, v120
    v_add_f32 v242, v242, v121
    ds_read_b64_tr_b16 v[172:173], v235 offset:57344
    ds_read_b64_tr_b16 v[174:175], v235 offset:59392
    s_waitcnt lgkmcnt(8)
    v_mfma_f32_32x32x16_bf16 v[48:63], v[188:191], v[100:103], v[48:63]
    v_add_f32 v241, v241, v122
    v_add_f32 v242, v242, v123
    v_cvt_pk_bf16_f32 v108, v120, v121
    v_cvt_pk_bf16_f32 v109, v122, v123
    v_exp_f32 v124, v124
    ds_read_b64_tr_b16 v[176:177], v232 offset:61440
    ds_read_b64_tr_b16 v[178:179], v232 offset:63488
    s_waitcnt lgkmcnt(8)
    v_mfma_f32_32x32x16_bf16 v[0:15], v[160:163], v[104:107], v[0:15]
    v_exp_f32 v125, v125
    ds_read_b64_tr_b16 v[180:181], v233 offset:61440
    ds_read_b64_tr_b16 v[182:183], v233 offset:63488
    s_waitcnt lgkmcnt(8)
    v_mfma_f32_32x32x16_bf16 v[16:31], v[164:167], v[104:107], v[16:31]
    v_exp_f32 v126, v126
    v_exp_f32 v127, v127
    ds_read_b64_tr_b16 v[184:185], v234 offset:61440
    ds_read_b64_tr_b16 v[186:187], v234 offset:63488
    s_waitcnt lgkmcnt(8)
    v_mfma_f32_32x32x16_bf16 v[32:47], v[168:171], v[104:107], v[32:47]
    v_add_f32 v241, v241, v124
    v_add_f32 v242, v242, v125
    v_add_f32 v241, v241, v126
    v_add_f32 v242, v242, v127
    v_cvt_pk_bf16_f32 v110, v124, v125
    v_cvt_pk_bf16_f32 v111, v126, v127
    ds_read_b64_tr_b16 v[188:189], v235 offset:61440
    ds_read_b64_tr_b16 v[190:191], v235 offset:63488
    s_waitcnt lgkmcnt(8)
    v_mfma_f32_32x32x16_bf16 v[48:63], v[172:175], v[104:107], v[48:63]
    v_max3_f32 v243, v64, v65, v66
    v_max3_f32 v244, v80, v81, v82
    v_max3_f32 v243, v243, v67, v68
    v_max3_f32 v244, v244, v83, v84
    s_waitcnt vmcnt(4)
    s_barrier
    ds_read_b128 v[160:163], v224 offset:49152
    s_waitcnt lgkmcnt(7)
    v_mfma_f32_32x32x16_bf16 v[0:15], v[176:179], v[108:111], v[0:15]
    v_max3_f32 v243, v243, v69, v70
    v_max3_f32 v244, v244, v85, v86
    v_max3_f32 v243, v243, v71, v72
    v_max3_f32 v244, v244, v87, v88
    ds_read_b128 v[164:167], v225 offset:49152
    s_waitcnt lgkmcnt(6)
    v_mfma_f32_32x32x16_bf16 v[16:31], v[180:183], v[108:111], v[16:31]
    v_max3_f32 v243, v243, v73, v74
    v_max3_f32 v244, v244, v89, v90
    v_max3_f32 v243, v243, v75, v76
    v_max3_f32 v244, v244, v91, v92
    s_add_u32 m0, s42, 16384
    s_nop 0
    buffer_load_dwordx4 v236, s[12:15], s40 offen lds
    ds_read_b128 v[168:171], v226 offset:49152
    s_waitcnt lgkmcnt(5)
    v_mfma_f32_32x32x16_bf16 v[32:47], v[184:187], v[108:111], v[32:47]
    v_max3_f32 v243, v243, v77, v78
    v_max3_f32 v244, v244, v93, v94
    v_max3_f32 v243, v243, v79, v95
    v_max_f32 v243, v243, v244
    ds_read_b128 v[172:175], v227 offset:49152
    s_waitcnt lgkmcnt(4)
    v_mfma_f32_32x32x16_bf16 v[48:63], v[188:191], v[108:111], v[48:63]
    v_mov_b32 v244, v243
    s_nop 1
    v_permlane32_swap_b32 v243, v244
    s_nop 1
    v_max_f32 v243, v243, v244
    v_cmp_lt_f32 vcc, 0x42400000, v243
    s_cbranch_vccnz L_resc_3
L_resc_ret_3:
    s_add_u32 s39, s39, 4
    s_branch L_attn_loop
L_attn_tail:
    s_waitcnt lgkmcnt(0)
    ds_read_b64_tr_b16 v[176:177], v232 offset:49152
    ds_read_b64_tr_b16 v[178:179], v232 offset:51200
    ds_read_b64_tr_b16 v[180:181], v233 offset:49152
    ds_read_b64_tr_b16 v[182:183], v233 offset:51200
    ds_read_b64_tr_b16 v[184:185], v234 offset:49152
    ds_read_b64_tr_b16 v[186:187], v234 offset:51200
    ds_read_b64_tr_b16 v[188:189], v235 offset:49152
    ds_read_b64_tr_b16 v[190:191], v235 offset:51200
    v_exp_f32 v96, v96
    v_exp_f32 v97, v97
    v_exp_f32 v98, v98
    v_exp_f32 v99, v99
    v_add_f32 v241, v241, v96
    v_add_f32 v242, v242, v97
    v_add_f32 v241, v241, v98
    v_add_f32 v242, v242, v99
    v_cvt_pk_bf16_f32 v96, v96, v97
    v_cvt_pk_bf16_f32 v97, v98, v99
    v_exp_f32 v100, v100
    v_exp_f32 v101, v101
    v_exp_f32 v102, v102
    v_exp_f32 v103, v103
    v_add_f32 v241, v241, v100
    v_add_f32 v242, v242, v101
    v_add_f32 v241, v241, v102
    v_add_f32 v242, v242, v103
    v_cvt_pk_bf16_f32 v98, v100, v101
    v_cvt_pk_bf16_f32 v99, v102, v103
    ds_read_b64_tr_b16 v[160:161], v232 offset:53248
    ds_read_b64_tr_b16 v[162:163], v232 offset:55296
    s_waitcnt lgkmcnt(8)
    v_mfma_f32_32x32x16_bf16 v[0:15], v[176:179], v[96:99], v[0:15]
    v_exp_f32 v104, v104
    v_exp_f32 v105, v105
    v_exp_f32 v106, v106
    v_exp_f32 v107, v107
    v_add_f32 v241, v241, v104
    ds_read_b64_tr_b16 v[164:165], v233 offset:53248
    ds_read_b64_tr_b16 v[166:167], v233 offset:55296
    s_waitcnt lgkmcnt(8)
    v_mfma_f32_32x32x16_bf16 v[16:31], v[180:183], v[96:99], v[16:31]
    v_add_f32 v242, v242, v105
    v_add_f32 v241, v241, v106
    v_add_f32 v242, v242, v107
    v_cvt_pk_bf16_f32 v100, v104, v105
    v_cvt_pk_bf16_f32 v101, v106, v107
    ds_read_b64_tr_b16 v[168:169], v234 offset:53248
    ds_read_b64_tr_b16 v[170:171], v234 offset:55296
    s_waitcnt lgkmcnt(8)
    v_mfma_f32_32x32x16_bf16 v[32:47], v[184:187], v[96:99], v[32:47]
    v_exp_f32 v108, v108
    v_exp_f32 v109, v109
    v_exp_f32 v110, v110
    v_exp_f32 v111, v111
    v_add_f32 v241, v241, v108
    ds_read_b64_tr_b16 v[172:173], v235 offset:53248
    ds_read_b64_tr_b16 v[174:175], v235 offset:55296
    s_waitcnt lgkmcnt(8)
    v_mfma_f32_32x32x16_bf16 v[48:63], v[188:191], v[96:99], v[48:63]
    v_add_f32 v242, v242, v109
    v_add_f32 v241, v241, v110
    v_add_f32 v242, v242, v111
    v_cvt_pk_bf16_f32 v102, v108, v109
    v_cvt_pk_bf16_f32 v103, v110, v111
    s_nop 1
    ds_read_b64_tr_b16 v[176:177], v232 offset:57344
    ds_read_b64_tr_b16 v[178:179], v232 offset:59392
    s_waitcnt lgkmcnt(8)
    v_mfma_f32_32x32x16_bf16 v[0:15], v[160:163], v[100:103], v[0:15]
    v_exp_f32 v112, v112
    v_exp_f32 v113, v113
    v_exp_f32 v114, v114
    v_exp_f32 v115, v115
    v_add_f32 v241, v241, v112
    ds_read_b64_tr_b16 v[180:181], v233 offset:57344
    ds_read_b64_tr_b16 v[182:183], v233 offset:59392
    s_waitcnt lgkmcnt(8)
    v_mfma_f32_32x32x16_bf16 v[16:31], v[164:167], v[100:103], v[16:31]
    v_add_f32 v242, v242, v113
    v_add_f32 v241, v241, v114
    v_add_f32 v242, v242, v115
    v_cvt_pk_bf16_f32 v104, v112, v113
    v_cvt_pk_bf16_f32 v105, v114, v115
    ds_read_b64_tr_b16 v[184:185], v234 offset:57344
    ds_read_b64_tr_b16 v[186:187], v234 offset:59392
    s_waitcnt lgkmcnt(8)
    v_mfma_f32_32x32x16_bf16 v[32:47], v[168:171], v[100:103], v[32:47]
    v_exp_f32 v116, v116
    v_exp_f32 v117, v117
    v_exp_f32 v118, v118
    v_exp_f32 v119, v119
    v_add_f32 v241, v241, v116
    ds_read_b64_tr_b16 v[188:189], v235 offset:57344
    ds_read_b64_tr_b16 v[190:191], v235 offset:59392
    s_waitcnt lgkmcnt(8)
    v_mfma_f32_32x32x16_bf16 v[48:63], v[172:175], v[100:103], v[48:63]
    v_add_f32 v242, v242, v117
    v_add_f32 v241, v241, v118
    v_add_f32 v242, v242, v119
    v_cvt_pk_bf16_f32 v106, v116, v117
    v_cvt_pk_bf16_f32 v107, v118, v119
    s_nop 1
    ds_read_b64_tr_b16 v[160:161], v232 offset:61440
    ds_read_b64_tr_b16 v[162:163], v232 offset:63488
    s_waitcnt lgkmcnt(8)
    v_mfma_f32_32x32x16_bf16 v[0:15], v[176:179], v[104:107], v[0:15]
    v_exp_f32 v120, v120
    v_exp_f32 v121, v121
    v_exp_f32 v122, v122
    v_exp_f32 v123, v123
    v_add_f32 v241, v241, v120
    ds_read_b64_tr_b16 v[164:165], v233 offset:61440
    ds_read_b64_tr_b16 v[166:167], v233 offset:63488
    s_waitcnt lgkmcnt(8)
    v_mfma_f32_32x32x16_bf16 v[16:31], v[180:183], v[104:107], v[16:31]
    v_add_f32 v242, v242, v121
    v_add_f32 v241, v241, v122
    v_add_f32 v242, v242, v123
    v_cvt_pk_bf16_f32 v108, v120, v121
    v_cvt_pk_bf16_f32 v109, v122, v123
    ds_read_b64_tr_b16 v[168:169], v234 offset:61440
    ds_read_b64_tr_b16 v[170:171], v234 offset:63488
    s_waitcnt lgkmcnt(8)
    v_mfma_f32_32x32x16_bf16 v[32:47], v[184:187], v[104:107], v[32:47]
    v_exp_f32 v124, v124
    v_exp_f32 v125, v125
    v_exp_f32 v126, v126
    v_exp_f32 v127, v127
    v_add_f32 v241, v241, v124
    ds_read_b64_tr_b16 v[172:173], v235 offset:61440
    ds_read_b64_tr_b16 v[174:175], v235 offset:63488
    s_waitcnt lgkmcnt(8)
    v_mfma_f32_32x32x16_bf16 v[48:63], v[188:191], v[104:107], v[48:63]
    v_add_f32 v242, v242, v125
    v_add_f32 v241, v241, v126
    v_add_f32 v242, v242, v127
    v_cvt_pk_bf16_f32 v110, v124, v125
    v_cvt_pk_bf16_f32 v111, v126, v127
    s_nop 1
    s_waitcnt lgkmcnt(6)
    v_mfma_f32_32x32x16_bf16 v[0:15], v[160:163], v[108:111], v[0:15]
    s_waitcnt lgkmcnt(4)
    v_mfma_f32_32x32x16_bf16 v[16:31], v[164:167], v[108:111], v[16:31]
    s_waitcnt lgkmcnt(2)
    v_mfma_f32_32x32x16_bf16 v[32:47], v[168:171], v[108:111], v[32:47]
    s_waitcnt lgkmcnt(0)
    v_mfma_f32_32x32x16_bf16 v[48:63], v[172:175], v[108:111], v[48:63]
L_attn_done:
    s_nop 15
    s_nop 3
    v_add_f32 v241, v241, v242
    v_mov_b32 v244, v241
    s_nop 1
    v_permlane32_swap_b32 v241, v244
    s_nop 1
    v_add_f32 v241, v241, v244
    v_rcp_f32 v241, v241
    s_nop 0
    v_mul_f32 v0, v0, v241
    v_mul_f32 v1, v1, v241
    v_mul_f32 v2, v2, v241
    v_mul_f32 v3, v3, v241
    v_mul_f32 v4, v4, v241
    v_mul_f32 v5, v5, v241
    v_mul_f32 v6, v6, v241
    v_mul_f32 v7, v7, v241
    v_mul_f32 v8, v8, v241
    v_mul_f32 v9, v9, v241
    v_mul_f32 v10, v10, v241
    v_mul_f32 v11, v11, v241
    v_mul_f32 v12, v12, v241
    v_mul_f32 v13, v13, v241
    v_mul_f32 v14, v14, v241
    v_mul_f32 v15, v15, v241
    v_cvt_pk_bf16_f32 v0, v0, v1
    v_cvt_pk_bf16_f32 v1, v2, v3
    v_cvt_pk_bf16_f32 v2, v4, v5
    v_cvt_pk_bf16_f32 v3, v6, v7
    v_cvt_pk_bf16_f32 v4, v8, v9
    v_cvt_pk_bf16_f32 v5, v10, v11
    v_cvt_pk_bf16_f32 v6, v12, v13
    v_cvt_pk_bf16_f32 v7, v14, v15
    buffer_store_dwordx4 v[0:3], v249, s[28:31], s46 offen offset:0
    buffer_store_dwordx4 v[4:7], v249, s[28:31], s46 offen offset:1024
    v_mul_f32 v16, v16, v241
    v_mul_f32 v17, v17, v241
    v_mul_f32 v18, v18, v241
    v_mul_f32 v19, v19, v241
    v_mul_f32 v20, v20, v241
    v_mul_f32 v21, v21, v241
    v_mul_f32 v22, v22, v241
    v_mul_f32 v23, v23, v241
    v_mul_f32 v24, v24, v241
    v_mul_f32 v25, v25, v241
    v_mul_f32 v26, v26, v241
    v_mul_f32 v27, v27, v241
    v_mul_f32 v28, v28, v241
    v_mul_f32 v29, v29, v241
    v_mul_f32 v30, v30, v241
    v_mul_f32 v31, v31, v241
    v_cvt_pk_bf16_f32 v16, v16, v17
    v_cvt_pk_bf16_f32 v17, v18, v19
    v_cvt_pk_bf16_f32 v18, v20, v21
    v_cvt_pk_bf16_f32 v19, v22, v23
    v_cvt_pk_bf16_f32 v20, v24, v25
    v_cvt_pk_bf16_f32 v21, v26, v27
    v_cvt_pk_bf16_f32 v22, v28, v29
    v_cvt_pk_bf16_f32 v23, v30, v31
    buffer_store_dwordx4 v[16:19], v249, s[28:31], s46 offen offset:2048
    buffer_store_dwordx4 v[20:23], v249, s[28:31], s46 offen offset:3072
    v_mul_f32 v32, v32, v241
    v_mul_f32 v33, v33, v241
    v_mul_f32 v34, v34, v241
    v_mul_f32 v35, v35, v241
    v_mul_f32 v36, v36, v241
    v_mul_f32 v37, v37, v241
    v_mul_f32 v38, v38, v241
    v_mul_f32 v39, v39, v241
    v_mul_f32 v40, v40, v241
    v_mul_f32 v41, v41, v241
    v_mul_f32 v42, v42, v241
    v_mul_f32 v43, v43, v241
    v_mul_f32 v44, v44, v241
    v_mul_f32 v45, v45, v241
    v_mul_f32 v46, v46, v241
    v_mul_f32 v47, v47, v241
    v_cvt_pk_bf16_f32 v32, v32, v33
    v_cvt_pk_bf16_f32 v33, v34, v35
    v_cvt_pk_bf16_f32 v34, v36, v37
    v_cvt_pk_bf16_f32 v35, v38, v39
    v_cvt_pk_bf16_f32 v36, v40, v41
    v_cvt_pk_bf16_f32 v37, v42, v43
    v_cvt_pk_bf16_f32 v38, v44, v45
    v_cvt_pk_bf16_f32 v39, v46, v47
    s_add_u32 s46, s46, 4096
    buffer_store_dwordx4 v[32:35], v249, s[28:31], s46 offen offset:0
    buffer_store_dwordx4 v[36:39], v249, s[28:31], s46 offen offset:1024
    v_mul_f32 v48, v48, v241
    v_mul_f32 v49, v49, v241
    v_mul_f32 v50, v50, v241
    v_mul_f32 v51, v51, v241
    v_mul_f32 v52, v52, v241
    v_mul_f32 v53, v53, v241
    v_mul_f32 v54, v54, v241
    v_mul_f32 v55, v55, v241
    v_mul_f32 v56, v56, v241
    v_mul_f32 v57, v57, v241
    v_mul_f32 v58, v58, v241
    v_mul_f32 v59, v59, v241
    v_mul_f32 v60, v60, v241
    v_mul_f32 v61, v61, v241
    v_mul_f32 v62, v62, v241
    v_mul_f32 v63, v63, v241
    v_cvt_pk_bf16_f32 v48, v48, v49
    v_cvt_pk_bf16_f32 v49, v50, v51
    v_cvt_pk_bf16_f32 v50, v52, v53
    v_cvt_pk_bf16_f32 v51, v54, v55
    v_cvt_pk_bf16_f32 v52, v56, v57
    v_cvt_pk_bf16_f32 v53, v58, v59
    v_cvt_pk_bf16_f32 v54, v60, v61
    v_cvt_pk_bf16_f32 v55, v62, v63
    buffer_store_dwordx4 v[48:51], v249, s[28:31], s46 offen offset:2048
    buffer_store_dwordx4 v[52:55], v249, s[28:31], s46 offen offset:3072
    s_branch L_attn_end
L_resc_0:
    s_nop 15
    s_nop 3
    v_max_f32 v243, 0, v243
    v_sub_f32 v245, 0, v243
    v_exp_f32 v245, v245
    v_sub_f32 v192, v192, v243
    v_mov_b32 v193, v192
    v_mov_b32 v194, v192
    v_mov_b32 v195, v192
    v_mov_b32 v196, v192
    v_mov_b32 v197, v192
    v_mov_b32 v198, v192
    v_mov_b32 v199, v192
    v_mov_b32 v200, v192
    v_mov_b32 v201, v192
    v_mov_b32 v202, v192
    v_mov_b32 v203, v192
    v_mov_b32 v204, v192
    v_mov_b32 v205, v192
    v_mov_b32 v206, v192
    v_mov_b32 v207, v192
    v_sub_f32 v96, v96, v243
    v_sub_f32 v97, v97, v243
    v_sub_f32 v98, v98, v243
    v_sub_f32 v99, v99, v243
    v_sub_f32 v100, v100, v243
    v_sub_f32 v101, v101, v243
    v_sub_f32 v102, v102, v243
    v_sub_f32 v103, v103, v243
    v_sub_f32 v104, v104, v243
    v_sub_f32 v105, v105, v243
    v_sub_f32 v106, v106, v243
    v_sub_f32 v107, v107, v243
    v_sub_f32 v108, v108, v243
    v_sub_f32 v109, v109, v243
    v_sub_f32 v110, v110, v243
    v_sub_f32 v111, v111, v243
    v_sub_f32 v112, v112, v243
    v_sub_f32 v113, v113, v243
    v_sub_f32 v114, v114, v243
    v_sub_f32 v115, v115, v243
    v_sub_f32 v116, v116, v243
    v_sub_f32 v117, v117, v243
    v_sub_f32 v118, v118, v243
    v_sub_f32 v119, v119, v243
    v_sub_f32 v120, v120, v243
    v_sub_f32 v121, v121, v243
    v_sub_f32 v122, v122, v243
    v_sub_f32 v123, v123, v243
    v_sub_f32 v124, v124, v243
    v_sub_f32 v125, v125, v243
    v_sub_f32 v126, v126, v243
    v_sub_f32 v127, v127, v243
    v_mul_f32 v0, v0, v245
    v_mul_f32 v1, v1, v245
    v_mul_f32 v2, v2, v245
    v_mul_f32 v3, v3, v245
    v_mul_f32 v4, v4, v245
    v_mul_f32 v5, v5, v245
    v_mul_f32 v6, v6, v245
    v_mul_f32 v7, v7, v245
    v_mul_f32 v8, v8, v245
    v_mul_f32 v9, v9, v245
    v_mul_f32 v10, v10, v245
    v_mul_f32 v11, v11, v245
    v_mul_f32 v12, v12, v245
    v_mul_f32 v13, v13, v245
    v_mul_f32 v14, v14, v245
    v_mul_f32 v15, v15, v245
    v_mul_f32 v16, v16, v245
    v_mul_f32 v17, v17, v245
    v_mul_f32 v18, v18, v245
    v_mul_f32 v19, v19, v245
    v_mul_f32 v20, v20, v245
    v_mul_f32 v21, v21, v245
    v_mul_f32 v22, v22, v245
    v_mul_f32 v23, v23, v245
    v_mul_f32 v24, v24, v245
    v_mul_f32 v25, v25, v245
    v_mul_f32 v26, v26, v245
    v_mul_f32 v27, v27, v245
    v_mul_f32 v28, v28, v245
    v_mul_f32 v29, v29, v245
    v_mul_f32 v30, v30, v245
    v_mul_f32 v31, v31, v245
    v_mul_f32 v32, v32, v245
    v_mul_f32 v33, v33, v245
    v_mul_f32 v34, v34, v245
    v_mul_f32 v35, v35, v245
    v_mul_f32 v36, v36, v245
    v_mul_f32 v37, v37, v245
    v_mul_f32 v38, v38, v245
    v_mul_f32 v39, v39, v245
    v_mul_f32 v40, v40, v245
    v_mul_f32 v41, v41, v245
    v_mul_f32 v42, v42, v245
    v_mul_f32 v43, v43, v245
    v_mul_f32 v44, v44, v245
    v_mul_f32 v45, v45, v245
    v_mul_f32 v46, v46, v245
    v_mul_f32 v47, v47, v245
    v_mul_f32 v48, v48, v245
    v_mul_f32 v49, v49, v245
    v_mul_f32 v50, v50, v245
    v_mul_f32 v51, v51, v245
    v_mul_f32 v52, v52, v245
    v_mul_f32 v53, v53, v245
    v_mul_f32 v54, v54, v245
    v_mul_f32 v55, v55, v245
    v_mul_f32 v56, v56, v245
    v_mul_f32 v57, v57, v245
    v_mul_f32 v58, v58, v245
    v_mul_f32 v59, v59, v245
    v_mul_f32 v60, v60, v245
    v_mul_f32 v61, v61, v245
    v_mul_f32 v62, v62, v245
    v_mul_f32 v63, v63, v245
    v_mul_f32 v241, v241, v245
    v_mul_f32 v242, v242, v245
    s_nop 1
    s_branch L_resc_ret_0
L_resc_1:
    s_nop 15
    s_nop 3
    v_max_f32 v243, 0, v243
    v_sub_f32 v245, 0, v243
    v_exp_f32 v245, v245
    v_sub_f32 v192, v192, v243
    v_mov_b32 v193, v192
    v_mov_b32 v194, v192
    v_mov_b32 v195, v192
    v_mov_b32 v196, v192
    v_mov_b32 v197, v192
    v_mov_b32 v198, v192
    v_mov_b32 v199, v192
    v_mov_b32 v200, v192
    v_mov_b32 v201, v192
    v_mov_b32 v202, v192
    v_mov_b32 v203, v192
    v_mov_b32 v204, v192
    v_mov_b32 v205, v192
    v_mov_b32 v206, v192
    v_mov_b32 v207, v192
    v_sub_f32 v64, v64, v243
    v_sub_f32 v65, v65, v243
    v_sub_f32 v66, v66, v243
    v_sub_f32 v67, v67, v243
    v_sub_f32 v68, v68, v243
    v_sub_f32 v69, v69, v243
    v_sub_f32 v70, v70, v243
    v_sub_f32 v71, v71, v243
    v_sub_f32 v72, v72, v243
    v_sub_f32 v73, v73, v243
    v_sub_f32 v74, v74, v243
    v_sub_f32 v75, v75, v243
    v_sub_f32 v76, v76, v243
    v_sub_f32 v77, v77, v243
    v_sub_f32 v78, v78, v243
    v_sub_f32 v79, v79, v243
    v_sub_f32 v80, v80, v243
    v_sub_f32 v81, v81, v243
    v_sub_f32 v82, v82, v243
    v_sub_f32 v83, v83, v243
    v_sub_f32 v84, v84, v243
    v_sub_f32 v85, v85, v243
    v_sub_f32 v86, v86, v243
    v_sub_f32 v87, v87, v243
    v_sub_f32 v88, v88, v243
    v_sub_f32 v89, v89, v243
    v_sub_f32 v90, v90, v243
    v_sub_f32 v91, v91, v243
    v_sub_f32 v92, v92, v243
    v_sub_f32 v93, v93, v243
    v_sub_f32 v94, v94, v243
    v_sub_f32 v95, v95, v243
    v_mul_f32 v0, v0, v245
    v_mul_f32 v1, v1, v245
    v_mul_f32 v2, v2, v245
    v_mul_f32 v3, v3, v245
    v_mul_f32 v4, v4, v245
    v_mul_f32 v5, v5, v245
    v_mul_f32 v6, v6, v245
    v_mul_f32 v7, v7, v245
    v_mul_f32 v8, v8, v245
    v_mul_f32 v9, v9, v245
    v_mul_f32 v10, v10, v245
    v_mul_f32 v11, v11, v245
    v_mul_f32 v12, v12, v245
    v_mul_f32 v13, v13, v245
    v_mul_f32 v14, v14, v245
    v_mul_f32 v15, v15, v245
    v_mul_f32 v16, v16, v245
    v_mul_f32 v17, v17, v245
    v_mul_f32 v18, v18, v245
    v_mul_f32 v19, v19, v245
    v_mul_f32 v20, v20, v245
    v_mul_f32 v21, v21, v245
    v_mul_f32 v22, v22, v245
    v_mul_f32 v23, v23, v245
    v_mul_f32 v24, v24, v245
    v_mul_f32 v25, v25, v245
    v_mul_f32 v26, v26, v245
    v_mul_f32 v27, v27, v245
    v_mul_f32 v28, v28, v245
    v_mul_f32 v29, v29, v245
    v_mul_f32 v30, v30, v245
    v_mul_f32 v31, v31, v245
    v_mul_f32 v32, v32, v245
    v_mul_f32 v33, v33, v245
    v_mul_f32 v34, v34, v245
    v_mul_f32 v35, v35, v245
    v_mul_f32 v36, v36, v245
    v_mul_f32 v37, v37, v245
    v_mul_f32 v38, v38, v245
    v_mul_f32 v39, v39, v245
    v_mul_f32 v40, v40, v245
    v_mul_f32 v41, v41, v245
    v_mul_f32 v42, v42, v245
    v_mul_f32 v43, v43, v245
    v_mul_f32 v44, v44, v245
    v_mul_f32 v45, v45, v245
    v_mul_f32 v46, v46, v245
    v_mul_f32 v47, v47, v245
    v_mul_f32 v48, v48, v245
    v_mul_f32 v49, v49, v245
    v_mul_f32 v50, v50, v245
    v_mul_f32 v51, v51, v245
    v_mul_f32 v52, v52, v245
    v_mul_f32 v53, v53, v245
    v_mul_f32 v54, v54, v245
    v_mul_f32 v55, v55, v245
    v_mul_f32 v56, v56, v245
    v_mul_f32 v57, v57, v245
    v_mul_f32 v58, v58, v245
    v_mul_f32 v59, v59, v245
    v_mul_f32 v60, v60, v245
    v_mul_f32 v61, v61, v245
    v_mul_f32 v62, v62, v245
    v_mul_f32 v63, v63, v245
    v_mul_f32 v241, v241, v245
    v_mul_f32 v242, v242, v245
    s_nop 1
    s_branch L_resc_ret_1
L_resc_2:
    s_nop 15
    s_nop 3
    v_max_f32 v243, 0, v243
    v_sub_f32 v245, 0, v243
    v_exp_f32 v245, v245
    v_sub_f32 v192, v192, v243
    v_mov_b32 v193, v192
    v_mov_b32 v194, v192
    v_mov_b32 v195, v192
    v_mov_b32 v196, v192
    v_mov_b32 v197, v192
    v_mov_b32 v198, v192
    v_mov_b32 v199, v192
    v_mov_b32 v200, v192
    v_mov_b32 v201, v192
    v_mov_b32 v202, v192
    v_mov_b32 v203, v192
    v_mov_b32 v204, v192
    v_mov_b32 v205, v192
    v_mov_b32 v206, v192
    v_mov_b32 v207, v192
    v_sub_f32 v96, v96, v243
    v_sub_f32 v97, v97, v243
    v_sub_f32 v98, v98, v243
    v_sub_f32 v99, v99, v243
    v_sub_f32 v100, v100, v243
    v_sub_f32 v101, v101, v243
    v_sub_f32 v102, v102, v243
    v_sub_f32 v103, v103, v243
    v_sub_f32 v104, v104, v243
    v_sub_f32 v105, v105, v243
    v_sub_f32 v106, v106, v243
    v_sub_f32 v107, v107, v243
    v_sub_f32 v108, v108, v243
    v_sub_f32 v109, v109, v243
    v_sub_f32 v110, v110, v243
    v_sub_f32 v111, v111, v243
    v_sub_f32 v112, v112, v243
    v_sub_f32 v113, v113, v243
    v_sub_f32 v114, v114, v243
    v_sub_f32 v115, v115, v243
    v_sub_f32 v116, v116, v243
    v_sub_f32 v117, v117, v243
    v_sub_f32 v118, v118, v243
    v_sub_f32 v119, v119, v243
    v_sub_f32 v120, v120, v243
    v_sub_f32 v121, v121, v243
    v_sub_f32 v122, v122, v243
    v_sub_f32 v123, v123, v243
    v_sub_f32 v124, v124, v243
    v_sub_f32 v125, v125, v243
    v_sub_f32 v126, v126, v243
    v_sub_f32 v127, v127, v243
    v_mul_f32 v0, v0, v245
    v_mul_f32 v1, v1, v245
    v_mul_f32 v2, v2, v245
    v_mul_f32 v3, v3, v245
    v_mul_f32 v4, v4, v245
    v_mul_f32 v5, v5, v245
    v_mul_f32 v6, v6, v245
    v_mul_f32 v7, v7, v245
    v_mul_f32 v8, v8, v245
    v_mul_f32 v9, v9, v245
    v_mul_f32 v10, v10, v245
    v_mul_f32 v11, v11, v245
    v_mul_f32 v12, v12, v245
    v_mul_f32 v13, v13, v245
    v_mul_f32 v14, v14, v245
    v_mul_f32 v15, v15, v245
    v_mul_f32 v16, v16, v245
    v_mul_f32 v17, v17, v245
    v_mul_f32 v18, v18, v245
    v_mul_f32 v19, v19, v245
    v_mul_f32 v20, v20, v245
    v_mul_f32 v21, v21, v245
    v_mul_f32 v22, v22, v245
    v_mul_f32 v23, v23, v245
    v_mul_f32 v24, v24, v245
    v_mul_f32 v25, v25, v245
    v_mul_f32 v26, v26, v245
    v_mul_f32 v27, v27, v245
    v_mul_f32 v28, v28, v245
    v_mul_f32 v29, v29, v245
    v_mul_f32 v30, v30, v245
    v_mul_f32 v31, v31, v245
    v_mul_f32 v32, v32, v245
    v_mul_f32 v33, v33, v245
    v_mul_f32 v34, v34, v245
    v_mul_f32 v35, v35, v245
    v_mul_f32 v36, v36, v245
    v_mul_f32 v37, v37, v245
    v_mul_f32 v38, v38, v245
    v_mul_f32 v39, v39, v245
    v_mul_f32 v40, v40, v245
    v_mul_f32 v41, v41, v245
    v_mul_f32 v42, v42, v245
    v_mul_f32 v43, v43, v245
    v_mul_f32 v44, v44, v245
    v_mul_f32 v45, v45, v245
    v_mul_f32 v46, v46, v245
    v_mul_f32 v47, v47, v245
    v_mul_f32 v48, v48, v245
    v_mul_f32 v49, v49, v245
    v_mul_f32 v50, v50, v245
    v_mul_f32 v51, v51, v245
    v_mul_f32 v52, v52, v245
    v_mul_f32 v53, v53, v245
    v_mul_f32 v54, v54, v245
    v_mul_f32 v55, v55, v245
    v_mul_f32 v56, v56, v245
    v_mul_f32 v57, v57, v245
    v_mul_f32 v58, v58, v245
    v_mul_f32 v59, v59, v245
    v_mul_f32 v60, v60, v245
    v_mul_f32 v61, v61, v245
    v_mul_f32 v62, v62, v245
    v_mul_f32 v63, v63, v245
    v_mul_f32 v241, v241, v245
    v_mul_f32 v242, v242, v245
    s_nop 1
    s_branch L_resc_ret_2
L_resc_3:
    s_nop 15
    s_nop 3
    v_max_f32 v243, 0, v243
    v_sub_f32 v245, 0, v243
    v_exp_f32 v245, v245
    v_sub_f32 v192, v192, v243
    v_mov_b32 v193, v192
    v_mov_b32 v194, v192
    v_mov_b32 v195, v192
    v_mov_b32 v196, v192
    v_mov_b32 v197, v192
    v_mov_b32 v198, v192
    v_mov_b32 v199, v192
    v_mov_b32 v200, v192
    v_mov_b32 v201, v192
    v_mov_b32 v202, v192
    v_mov_b32 v203, v192
    v_mov_b32 v204, v192
    v_mov_b32 v205, v192
    v_mov_b32 v206, v192
    v_mov_b32 v207, v192
    v_sub_f32 v64, v64, v243
    v_sub_f32 v65, v65, v243
    v_sub_f32 v66, v66, v243
    v_sub_f32 v67, v67, v243
    v_sub_f32 v68, v68, v243
    v_sub_f32 v69, v69, v243
    v_sub_f32 v70, v70, v243
    v_sub_f32 v71, v71, v243
    v_sub_f32 v72, v72, v243
    v_sub_f32 v73, v73, v243
    v_sub_f32 v74, v74, v243
    v_sub_f32 v75, v75, v243
    v_sub_f32 v76, v76, v243
    v_sub_f32 v77, v77, v243
    v_sub_f32 v78, v78, v243
    v_sub_f32 v79, v79, v243
    v_sub_f32 v80, v80, v243
    v_sub_f32 v81, v81, v243
    v_sub_f32 v82, v82, v243
    v_sub_f32 v83, v83, v243
    v_sub_f32 v84, v84, v243
    v_sub_f32 v85, v85, v243
    v_sub_f32 v86, v86, v243
    v_sub_f32 v87, v87, v243
    v_sub_f32 v88, v88, v243
    v_sub_f32 v89, v89, v243
    v_sub_f32 v90, v90, v243
    v_sub_f32 v91, v91, v243
    v_sub_f32 v92, v92, v243
    v_sub_f32 v93, v93, v243
    v_sub_f32 v94, v94, v243
    v_sub_f32 v95, v95, v243
    v_mul_f32 v0, v0, v245
    v_mul_f32 v1, v1, v245
    v_mul_f32 v2, v2, v245
    v_mul_f32 v3, v3, v245
    v_mul_f32 v4, v4, v245
    v_mul_f32 v5, v5, v245
    v_mul_f32 v6, v6, v245
    v_mul_f32 v7, v7, v245
    v_mul_f32 v8, v8, v245
    v_mul_f32 v9, v9, v245
    v_mul_f32 v10, v10, v245
    v_mul_f32 v11, v11, v245
    v_mul_f32 v12, v12, v245
    v_mul_f32 v13, v13, v245
    v_mul_f32 v14, v14, v245
    v_mul_f32 v15, v15, v245
    v_mul_f32 v16, v16, v245
    v_mul_f32 v17, v17, v245
    v_mul_f32 v18, v18, v245
    v_mul_f32 v19, v19, v245
    v_mul_f32 v20, v20, v245
    v_mul_f32 v21, v21, v245
    v_mul_f32 v22, v22, v245
    v_mul_f32 v23, v23, v245
    v_mul_f32 v24, v24, v245
    v_mul_f32 v25, v25, v245
    v_mul_f32 v26, v26, v245
    v_mul_f32 v27, v27, v245
    v_mul_f32 v28, v28, v245
    v_mul_f32 v29, v29, v245
    v_mul_f32 v30, v30, v245
    v_mul_f32 v31, v31, v245
    v_mul_f32 v32, v32, v245
    v_mul_f32 v33, v33, v245
    v_mul_f32 v34, v34, v245
    v_mul_f32 v35, v35, v245
    v_mul_f32 v36, v36, v245
    v_mul_f32 v37, v37, v245
    v_mul_f32 v38, v38, v245
    v_mul_f32 v39, v39, v245
    v_mul_f32 v40, v40, v245
    v_mul_f32 v41, v41, v245
    v_mul_f32 v42, v42, v245
    v_mul_f32 v43, v43, v245
    v_mul_f32 v44, v44, v245
    v_mul_f32 v45, v45, v245
    v_mul_f32 v46, v46, v245
    v_mul_f32 v47, v47, v245
    v_mul_f32 v48, v48, v245
    v_mul_f32 v49, v49, v245
    v_mul_f32 v50, v50, v245
    v_mul_f32 v51, v51, v245
    v_mul_f32 v52, v52, v245
    v_mul_f32 v53, v53, v245
    v_mul_f32 v54, v54, v245
    v_mul_f32 v55, v55, v245
    v_mul_f32 v56, v56, v245
    v_mul_f32 v57, v57, v245
    v_mul_f32 v58, v58, v245
    v_mul_f32 v59, v59, v245
    v_mul_f32 v60, v60, v245
    v_mul_f32 v61, v61, v245
    v_mul_f32 v62, v62, v245
    v_mul_f32 v63, v63, v245
    v_mul_f32 v241, v241, v245
    v_mul_f32 v242, v242, v245
    s_nop 1
    s_branch L_resc_ret_3
L_attn_end:
    s_endpgm
.globl outp_kernel
.p2align 8
.type outp_kernel,@function
outp_kernel:
    s_cmp_ge_u32 s2, 256
    s_cbranch_scc1 L_outp_end
    s_load_dwordx2 s[4:5], s[0:1], 0
    s_load_dwordx2 s[6:7], s[0:1], 32
    s_load_dwordx2 s[8:9], s[0:1], 64
    s_load_dwordx2 s[10:11], s[0:1], 72
    s_load_dwordx2 s[12:13], s[0:1], 88
    v_and_b32 v224, 63, v0
    v_lshrrev_b32 v225, 6, v0
    s_and_b32 s40, s2, 31
    s_lshr_b32 s41, s2, 5
    v_readfirstlane_b32 s42, v225
    s_waitcnt lgkmcnt(0)
    s_mov_b32 s16, s4
    s_and_b32 s17, s5, 0xffff
    s_mov_b32 s18, 0x200000
    s_mov_b32 s19, 0x00020000
    s_add_u32 s20, s12, 0x2000000
    s_addc_u32 s21, s13, 0
    s_and_b32 s21, s21, 0xffff
    s_mov_b32 s22, 0x5c0000
    s_mov_b32 s23, 0x00020000
    s_mov_b32 s28, s10
    s_and_b32 s29, s11, 0xffff
    s_mov_b32 s30, 0x200000
    s_mov_b32 s31, 0x00020000
    s_add_u32 s32, s12, 0x1000000
    s_addc_u32 s33, s13, 0
    s_and_b32 s33, s33, 0xffff
    s_mov_b32 s34, 0x1000000
    s_mov_b32 s35, 0x00020000
    s_add_u32 s36, s12, 0x200000
    s_addc_u32 s37, s13, 0
    s_and_b32 s37, s37, 0xffff
    s_mov_b32 s38, 0x700000
    s_mov_b32 s39, 0x00020000
    v_lshlrev_b32 v233, 4, v224
    s_mul_i32 s47, s40, 524288
    s_lshl_b32 s43, s42, 11
    s_add_u32 s47, s47, s43
    s_mul_i32 s48, s40, 229376
    s_lshl_b32 s43, s42, 11
    s_add_u32 s48, s48, s43
    s_mul_i32 s49, s41, 753664
    s_lshl_b32 s43, s42, 11
    s_add_u32 s49, s49, s43
    s_add_u32 s43, s49, 0
    buffer_load_dwordx4 v[144:147], v233, s[20:23], s43 offen offset:0
    buffer_load_dwordx4 v[152:155], v233, s[20:23], s43 offen offset:1024
    s_add_u32 s43, s49, 376832
    buffer_load_dwordx4 v[148:151], v233, s[20:23], s43 offen offset:0
    buffer_load_dwordx4 v[156:159], v233, s[20:23], s43 offen offset:1024
    s_add_u32 s43, s47, 0
    buffer_load_dwordx4 v[128:131], v233, s[32:35], s43 offen offset:0
    buffer_load_dwordx4 v[136:139], v233, s[32:35], s43 offen offset:1024
    s_add_u32 s43, s47, 262144
    buffer_load_dwordx4 v[132:135], v233, s[32:35], s43 offen offset:0
    buffer_load_dwordx4 v[140:143], v233, s[32:35], s43 offen offset:1024
    s_add_u32 s43, s49, 16384
    buffer_load_dwordx4 v[176:179], v233, s[20:23], s43 offen offset:0
    buffer_load_dwordx4 v[184:187], v233, s[20:23], s43 offen offset:1024
    s_add_u32 s43, s49, 393216
    buffer_load_dwordx4 v[180:183], v233, s[20:23], s43 offen offset:0
    buffer_load_dwordx4 v[188:191], v233, s[20:23], s43 offen offset:1024
    s_add_u32 s43, s47, 16384
    buffer_load_dwordx4 v[160:163], v233, s[32:35], s43 offen offset:0
    buffer_load_dwordx4 v[168:171], v233, s[32:35], s43 offen offset:1024
    s_add_u32 s43, s47, 278528
    buffer_load_dwordx4 v[164:167], v233, s[32:35], s43 offen offset:0
    buffer_load_dwordx4 v[172:175], v233, s[32:35], s43 offen offset:1024
    s_add_u32 s43, s49, 32768
    buffer_load_dwordx4 v[208:211], v233, s[20:23], s43 offen offset:0
    buffer_load_dwordx4 v[216:219], v233, s[20:23], s43 offen offset:1024
    s_add_u32 s43, s49, 409600
    buffer_load_dwordx4 v[212:215], v233, s[20:23], s43 offen offset:0
    buffer_load_dwordx4 v[220:223], v233, s[20:23], s43 offen offset:1024
    s_add_u32 s43, s47, 32768
    buffer_load_dwordx4 v[192:195], v233, s[32:35], s43 offen offset:0
    buffer_load_dwordx4 v[200:203], v233, s[32:35], s43 offen offset:1024
    s_add_u32 s43, s47, 294912
    buffer_load_dwordx4 v[196:199], v233, s[32:35], s43 offen offset:0
    buffer_load_dwordx4 v[204:207], v233, s[32:35], s43 offen offset:1024
    s_waitcnt vmcnt(16)
    v_mfma_f32_32x32x16_bf16 v[0:15], v[144:147], v[128:131], 0
    v_mfma_f32_32x32x16_bf16 v[16:31], v[144:147], v[132:135], 0
    v_mfma_f32_32x32x16_bf16 v[32:47], v[148:151], v[128:131], 0
    v_mfma_f32_32x32x16_bf16 v[48:63], v[148:151], v[132:135], 0
    v_mfma_f32_32x32x16_bf16 v[0:15], v[152:155], v[136:139], v[0:15]
    v_mfma_f32_32x32x16_bf16 v[16:31], v[152:155], v[140:143], v[16:31]
    v_mfma_f32_32x32x16_bf16 v[32:47], v[156:159], v[136:139], v[32:47]
    v_mfma_f32_32x32x16_bf16 v[48:63], v[156:159], v[140:143], v[48:63]
    s_add_u32 s43, s49, 49152
    buffer_load_dwordx4 v[144:147], v233, s[20:23], s43 offen offset:0
    buffer_load_dwordx4 v[152:155], v233, s[20:23], s43 offen offset:1024
    s_add_u32 s43, s49, 425984
    buffer_load_dwordx4 v[148:151], v233, s[20:23], s43 offen offset:0
    buffer_load_dwordx4 v[156:159], v233, s[20:23], s43 offen offset:1024
    s_add_u32 s43, s47, 49152
    buffer_load_dwordx4 v[128:131], v233, s[32:35], s43 offen offset:0
    buffer_load_dwordx4 v[136:139], v233, s[32:35], s43 offen offset:1024
    s_add_u32 s43, s47, 311296
    buffer_load_dwordx4 v[132:135], v233, s[32:35], s43 offen offset:0
    buffer_load_dwordx4 v[140:143], v233, s[32:35], s43 offen offset:1024
    s_waitcnt vmcnt(16)
    v_mfma_f32_32x32x16_bf16 v[0:15], v[176:179], v[160:163], v[0:15]
    v_mfma_f32_32x32x16_bf16 v[16:31], v[176:179], v[164:167], v[16:31]
    v_mfma_f32_32x32x16_bf16 v[32:47], v[180:183], v[160:163], v[32:47]
    v_mfma_f32_32x32x16_bf16 v[48:63], v[180:183], v[164:167], v[48:63]
    v_mfma_f32_32x32x16_bf16 v[0:15], v[184:187], v[168:171], v[0:15]
    v_mfma_f32_32x32x16_bf16 v[16:31], v[184:187], v[172:175], v[16:31]
    v_mfma_f32_32x32x16_bf16 v[32:47], v[188:191], v[168:171], v[32:47]
    v_mfma_f32_32x32x16_bf16 v[48:63], v[188:191], v[172:175], v[48:63]
    s_add_u32 s43, s49, 65536
    buffer_load_dwordx4 v[176:179], v233, s[20:23], s43 offen offset:0
    buffer_load_dwordx4 v[184:187], v233, s[20:23], s43 offen offset:1024
    s_add_u32 s43, s49, 442368
    buffer_load_dwordx4 v[180:183], v233, s[20:23], s43 offen offset:0
    buffer_load_dwordx4 v[188:191], v233, s[20:23], s43 offen offset:1024
    s_add_u32 s43, s47, 65536
    buffer_load_dwordx4 v[160:163], v233, s[32:35], s43 offen offset:0
    buffer_load_dwordx4 v[168:171], v233, s[32:35], s43 offen offset:1024
    s_add_u32 s43, s47, 327680
    buffer_load_dwordx4 v[164:167], v233, s[32:35], s43 offen offset:0
    buffer_load_dwordx4 v[172:175], v233, s[32:35], s43 offen offset:1024
    s_waitcnt vmcnt(16)
    v_mfma_f32_32x32x16_bf16 v[0:15], v[208:211], v[192:195], v[0:15]
    v_mfma_f32_32x32x16_bf16 v[16:31], v[208:211], v[196:199], v[16:31]
    v_mfma_f32_32x32x16_bf16 v[32:47], v[212:215], v[192:195], v[32:47]
    v_mfma_f32_32x32x16_bf16 v[48:63], v[212:215], v[196:199], v[48:63]
    v_mfma_f32_32x32x16_bf16 v[0:15], v[216:219], v[200:203], v[0:15]
    v_mfma_f32_32x32x16_bf16 v[16:31], v[216:219], v[204:207], v[16:31]
    v_mfma_f32_32x32x16_bf16 v[32:47], v[220:223], v[200:203], v[32:47]
    v_mfma_f32_32x32x16_bf16 v[48:63], v[220:223], v[204:207], v[48:63]
    s_add_u32 s43, s49, 81920
    buffer_load_dwordx4 v[208:211], v233, s[20:23], s43 offen offset:0
    buffer_load_dwordx4 v[216:219], v233, s[20:23], s43 offen offset:1024
    s_add_u32 s43, s49, 458752
    buffer_load_dwordx4 v[212:215], v233, s[20:23], s43 offen offset:0
    buffer_load_dwordx4 v[220:223], v233, s[20:23], s43 offen offset:1024
    s_add_u32 s43, s47, 81920
    buffer_load_dwordx4 v[192:195], v233, s[32:35], s43 offen offset:0
    buffer_load_dwordx4 v[200:203], v233, s[32:35], s43 offen offset:1024
    s_add_u32 s43, s47, 344064
    buffer_load_dwordx4 v[196:199], v233, s[32:35], s43 offen offset:0
    buffer_load_dwordx4 v[204:207], v233, s[32:35], s43 offen offset:1024
    s_waitcnt vmcnt(16)
    v_mfma_f32_32x32x16_bf16 v[0:15], v[144:147], v[128:131], v[0:15]
    v_mfma_f32_32x32x16_bf16 v[16:31], v[144:147], v[132:135], v[16:31]
    v_mfma_f32_32x32x16_bf16 v[32:47], v[148:151], v[128:131], v[32:47]
    v_mfma_f32_32x32x16_bf16 v[48:63], v[148:151], v[132:135], v[48:63]
    v_mfma_f32_32x32x16_bf16 v[0:15], v[152:155], v[136:139], v[0:15]
    v_mfma_f32_32x32x16_bf16 v[16:31], v[152:155], v[140:143], v[16:31]
    v_mfma_f32_32x32x16_bf16 v[32:47], v[156:159], v[136:139], v[32:47]
    v_mfma_f32_32x32x16_bf16 v[48:63], v[156:159], v[140:143], v[48:63]
    s_add_u32 s43, s49, 98304
    buffer_load_dwordx4 v[144:147], v233, s[20:23], s43 offen offset:0
    buffer_load_dwordx4 v[152:155], v233, s[20:23], s43 offen offset:1024
    s_add_u32 s43, s49, 475136
    buffer_load_dwordx4 v[148:151], v233, s[20:23], s43 offen offset:0
    buffer_load_dwordx4 v[156:159], v233, s[20:23], s43 offen offset:1024
    s_add_u32 s43, s47, 98304
    buffer_load_dwordx4 v[128:131], v233, s[32:35], s43 offen offset:0
    buffer_load_dwordx4 v[136:139], v233, s[32:35], s43 offen offset:1024
    s_add_u32 s43, s47, 360448
    buffer_load_dwordx4 v[132:135], v233, s[32:35], s43 offen offset:0
    buffer_load_dwordx4 v[140:143], v233, s[32:35], s43 offen offset:1024
    s_waitcnt vmcnt(16)
    v_mfma_f32_32x32x16_bf16 v[0:15], v[176:179], v[160:163], v[0:15]
    v_mfma_f32_32x32x16_bf16 v[16:31], v[176:179], v[164:167], v[16:31]
    v_mfma_f32_32x32x16_bf16 v[32:47], v[180:183], v[160:163], v[32:47]
    v_mfma_f32_32x32x16_bf16 v[48:63], v[180:183], v[164:167], v[48:63]
    v_mfma_f32_32x32x16_bf16 v[0:15], v[184:187], v[168:171], v[0:15]
    v_mfma_f32_32x32x16_bf16 v[16:31], v[184:187], v[172:175], v[16:31]
    v_mfma_f32_32x32x16_bf16 v[32:47], v[188:191], v[168:171], v[32:47]
    v_mfma_f32_32x32x16_bf16 v[48:63], v[188:191], v[172:175], v[48:63]
    s_add_u32 s43, s49, 114688
    buffer_load_dwordx4 v[176:179], v233, s[20:23], s43 offen offset:0
    buffer_load_dwordx4 v[184:187], v233, s[20:23], s43 offen offset:1024
    s_add_u32 s43, s49, 491520
    buffer_load_dwordx4 v[180:183], v233, s[20:23], s43 offen offset:0
    buffer_load_dwordx4 v[188:191], v233, s[20:23], s43 offen offset:1024
    s_add_u32 s43, s47, 114688
    buffer_load_dwordx4 v[160:163], v233, s[32:35], s43 offen offset:0
    buffer_load_dwordx4 v[168:171], v233, s[32:35], s43 offen offset:1024
    s_add_u32 s43, s47, 376832
    buffer_load_dwordx4 v[164:167], v233, s[32:35], s43 offen offset:0
    buffer_load_dwordx4 v[172:175], v233, s[32:35], s43 offen offset:1024
    s_waitcnt vmcnt(16)
    v_mfma_f32_32x32x16_bf16 v[0:15], v[208:211], v[192:195], v[0:15]
    v_mfma_f32_32x32x16_bf16 v[16:31], v[208:211], v[196:199], v[16:31]
    v_mfma_f32_32x32x16_bf16 v[32:47], v[212:215], v[192:195], v[32:47]
    v_mfma_f32_32x32x16_bf16 v[48:63], v[212:215], v[196:199], v[48:63]
    v_mfma_f32_32x32x16_bf16 v[0:15], v[216:219], v[200:203], v[0:15]
    v_mfma_f32_32x32x16_bf16 v[16:31], v[216:219], v[204:207], v[16:31]
    v_mfma_f32_32x32x16_bf16 v[32:47], v[220:223], v[200:203], v[32:47]
    v_mfma_f32_32x32x16_bf16 v[48:63], v[220:223], v[204:207], v[48:63]
    s_add_u32 s43, s49, 131072
    buffer_load_dwordx4 v[208:211], v233, s[20:23], s43 offen offset:0
    buffer_load_dwordx4 v[216:219], v233, s[20:23], s43 offen offset:1024
    s_add_u32 s43, s49, 507904
    buffer_load_dwordx4 v[212:215], v233, s[20:23], s43 offen offset:0
    buffer_load_dwordx4 v[220:223], v233, s[20:23], s43 offen offset:1024
    s_add_u32 s43, s47, 131072
    buffer_load_dwordx4 v[192:195], v233, s[32:35], s43 offen offset:0
    buffer_load_dwordx4 v[200:203], v233, s[32:35], s43 offen offset:1024
    s_add_u32 s43, s47, 393216
    buffer_load_dwordx4 v[196:199], v233, s[32:35], s43 offen offset:0
    buffer_load_dwordx4 v[204:207], v233, s[32:35], s43 offen offset:1024
    s_waitcnt vmcnt(16)
    v_mfma_f32_32x32x16_bf16 v[0:15], v[144:147], v[128:131], v[0:15]
    v_mfma_f32_32x32x16_bf16 v[16:31], v[144:147], v[132:135], v[16:31]
    v_mfma_f32_32x32x16_bf16 v[32:47], v[148:151], v[128:131], v[32:47]
    v_mfma_f32_32x32x16_bf16 v[48:63], v[148:151], v[132:135], v[48:63]
    v_mfma_f32_32x32x16_bf16 v[0:15], v[152:155], v[136:139], v[0:15]
    v_mfma_f32_32x32x16_bf16 v[16:31], v[152:155], v[140:143], v[16:31]
    v_mfma_f32_32x32x16_bf16 v[32:47], v[156:159], v[136:139], v[32:47]
    v_mfma_f32_32x32x16_bf16 v[48:63], v[156:159], v[140:143], v[48:63]
    s_add_u32 s43, s49, 147456
    buffer_load_dwordx4 v[144:147], v233, s[20:23], s43 offen offset:0
    buffer_load_dwordx4 v[152:155], v233, s[20:23], s43 offen offset:1024
    s_add_u32 s43, s49, 524288
    buffer_load_dwordx4 v[148:151], v233, s[20:23], s43 offen offset:0
    buffer_load_dwordx4 v[156:159], v233, s[20:23], s43 offen offset:1024
    s_add_u32 s43, s47, 147456
    buffer_load_dwordx4 v[128:131], v233, s[32:35], s43 offen offset:0
    buffer_load_dwordx4 v[136:139], v233, s[32:35], s43 offen offset:1024
    s_add_u32 s43, s47, 409600
    buffer_load_dwordx4 v[132:135], v233, s[32:35], s43 offen offset:0
    buffer_load_dwordx4 v[140:143], v233, s[32:35], s43 offen offset:1024
    s_waitcnt vmcnt(16)
    v_mfma_f32_32x32x16_bf16 v[0:15], v[176:179], v[160:163], v[0:15]
    v_mfma_f32_32x32x16_bf16 v[16:31], v[176:179], v[164:167], v[16:31]
    v_mfma_f32_32x32x16_bf16 v[32:47], v[180:183], v[160:163], v[32:47]
    v_mfma_f32_32x32x16_bf16 v[48:63], v[180:183], v[164:167], v[48:63]
    v_mfma_f32_32x32x16_bf16 v[0:15], v[184:187], v[168:171], v[0:15]
    v_mfma_f32_32x32x16_bf16 v[16:31], v[184:187], v[172:175], v[16:31]
    v_mfma_f32_32x32x16_bf16 v[32:47], v[188:191], v[168:171], v[32:47]
    v_mfma_f32_32x32x16_bf16 v[48:63], v[188:191], v[172:175], v[48:63]
    s_add_u32 s43, s49, 163840
    buffer_load_dwordx4 v[176:179], v233, s[20:23], s43 offen offset:0
    buffer_load_dwordx4 v[184:187], v233, s[20:23], s43 offen offset:1024
    s_add_u32 s43, s49, 540672
    buffer_load_dwordx4 v[180:183], v233, s[20:23], s43 offen offset:0
    buffer_load_dwordx4 v[188:191], v233, s[20:23], s43 offen offset:1024
    s_add_u32 s43, s47, 163840
    buffer_load_dwordx4 v[160:163], v233, s[32:35], s43 offen offset:0
    buffer_load_dwordx4 v[168:171], v233, s[32:35], s43 offen offset:1024
    s_add_u32 s43, s47, 425984
    buffer_load_dwordx4 v[164:167], v233, s[32:35], s43 offen offset:0
    buffer_load_dwordx4 v[172:175], v233, s[32:35], s43 offen offset:1024
    s_waitcnt vmcnt(16)
    v_mfma_f32_32x32x16_bf16 v[0:15], v[208:211], v[192:195], v[0:15]
    v_mfma_f32_32x32x16_bf16 v[16:31], v[208:211], v[196:199], v[16:31]
    v_mfma_f32_32x32x16_bf16 v[32:47], v[212:215], v[192:195], v[32:47]
    v_mfma_f32_32x32x16_bf16 v[48:63], v[212:215], v[196:199], v[48:63]
    v_mfma_f32_32x32x16_bf16 v[0:15], v[216:219], v[200:203], v[0:15]
    v_mfma_f32_32x32x16_bf16 v[16:31], v[216:219], v[204:207], v[16:31]
    v_mfma_f32_32x32x16_bf16 v[32:47], v[220:223], v[200:203], v[32:47]
    v_mfma_f32_32x32x16_bf16 v[48:63], v[220:223], v[204:207], v[48:63]
    s_add_u32 s43, s49, 180224
    buffer_load_dwordx4 v[208:211], v233, s[20:23], s43 offen offset:0
    buffer_load_dwordx4 v[216:219], v233, s[20:23], s43 offen offset:1024
    s_add_u32 s43, s49, 557056
    buffer_load_dwordx4 v[212:215], v233, s[20:23], s43 offen offset:0
    buffer_load_dwordx4 v[220:223], v233, s[20:23], s43 offen offset:1024
    s_add_u32 s43, s47, 180224
    buffer_load_dwordx4 v[192:195], v233, s[32:35], s43 offen offset:0
    buffer_load_dwordx4 v[200:203], v233, s[32:35], s43 offen offset:1024
    s_add_u32 s43, s47, 442368
    buffer_load_dwordx4 v[196:199], v233, s[32:35], s43 offen offset:0
    buffer_load_dwordx4 v[204:207], v233, s[32:35], s43 offen offset:1024
    s_waitcnt vmcnt(16)
    v_mfma_f32_32x32x16_bf16 v[0:15], v[144:147], v[128:131], v[0:15]
    v_mfma_f32_32x32x16_bf16 v[16:31], v[144:147], v[132:135], v[16:31]
    v_mfma_f32_32x32x16_bf16 v[32:47], v[148:151], v[128:131], v[32:47]
    v_mfma_f32_32x32x16_bf16 v[48:63], v[148:151], v[132:135], v[48:63]
    v_mfma_f32_32x32x16_bf16 v[0:15], v[152:155], v[136:139], v[0:15]
    v_mfma_f32_32x32x16_bf16 v[16:31], v[152:155], v[140:143], v[16:31]
    v_mfma_f32_32x32x16_bf16 v[32:47], v[156:159], v[136:139], v[32:47]
    v_mfma_f32_32x32x16_bf16 v[48:63], v[156:159], v[140:143], v[48:63]
    s_add_u32 s43, s49, 196608
    buffer_load_dwordx4 v[144:147], v233, s[20:23], s43 offen offset:0
    buffer_load_dwordx4 v[152:155], v233, s[20:23], s43 offen offset:1024
    s_add_u32 s43, s49, 573440
    buffer_load_dwordx4 v[148:151], v233, s[20:23], s43 offen offset:0
    buffer_load_dwordx4 v[156:159], v233, s[20:23], s43 offen offset:1024
    s_add_u32 s43, s47, 196608
    buffer_load_dwordx4 v[128:131], v233, s[32:35], s43 offen offset:0
    buffer_load_dwordx4 v[136:139], v233, s[32:35], s43 offen offset:1024
    s_add_u32 s43, s47, 458752
    buffer_load_dwordx4 v[132:135], v233, s[32:35], s43 offen offset:0
    buffer_load_dwordx4 v[140:143], v233, s[32:35], s43 offen offset:1024
    s_waitcnt vmcnt(16)
    v_mfma_f32_32x32x16_bf16 v[0:15], v[176:179], v[160:163], v[0:15]
    v_mfma_f32_32x32x16_bf16 v[16:31], v[176:179], v[164:167], v[16:31]
    v_mfma_f32_32x32x16_bf16 v[32:47], v[180:183], v[160:163], v[32:47]
    v_mfma_f32_32x32x16_bf16 v[48:63], v[180:183], v[164:167], v[48:63]
    v_mfma_f32_32x32x16_bf16 v[0:15], v[184:187], v[168:171], v[0:15]
    v_mfma_f32_32x32x16_bf16 v[16:31], v[184:187], v[172:175], v[16:31]
    v_mfma_f32_32x32x16_bf16 v[32:47], v[188:191], v[168:171], v[32:47]
    v_mfma_f32_32x32x16_bf16 v[48:63], v[188:191], v[172:175], v[48:63]
    s_add_u32 s43, s49, 212992
    buffer_load_dwordx4 v[176:179], v233, s[20:23], s43 offen offset:0
    buffer_load_dwordx4 v[184:187], v233, s[20:23], s43 offen offset:1024
    s_add_u32 s43, s49, 589824
    buffer_load_dwordx4 v[180:183], v233, s[20:23], s43 offen offset:0
    buffer_load_dwordx4 v[188:191], v233, s[20:23], s43 offen offset:1024
    s_add_u32 s43, s47, 212992
    buffer_load_dwordx4 v[160:163], v233, s[32:35], s43 offen offset:0
    buffer_load_dwordx4 v[168:171], v233, s[32:35], s43 offen offset:1024
    s_add_u32 s43, s47, 475136
    buffer_load_dwordx4 v[164:167], v233, s[32:35], s43 offen offset:0
    buffer_load_dwordx4 v[172:175], v233, s[32:35], s43 offen offset:1024
    s_waitcnt vmcnt(16)
    v_mfma_f32_32x32x16_bf16 v[0:15], v[208:211], v[192:195], v[0:15]
    v_mfma_f32_32x32x16_bf16 v[16:31], v[208:211], v[196:199], v[16:31]
    v_mfma_f32_32x32x16_bf16 v[32:47], v[212:215], v[192:195], v[32:47]
    v_mfma_f32_32x32x16_bf16 v[48:63], v[212:215], v[196:199], v[48:63]
    v_mfma_f32_32x32x16_bf16 v[0:15], v[216:219], v[200:203], v[0:15]
    v_mfma_f32_32x32x16_bf16 v[16:31], v[216:219], v[204:207], v[16:31]
    v_mfma_f32_32x32x16_bf16 v[32:47], v[220:223], v[200:203], v[32:47]
    v_mfma_f32_32x32x16_bf16 v[48:63], v[220:223], v[204:207], v[48:63]
    s_add_u32 s43, s49, 229376
    buffer_load_dwordx4 v[208:211], v233, s[20:23], s43 offen offset:0
    buffer_load_dwordx4 v[216:219], v233, s[20:23], s43 offen offset:1024
    s_add_u32 s43, s49, 606208
    buffer_load_dwordx4 v[212:215], v233, s[20:23], s43 offen offset:0
    buffer_load_dwordx4 v[220:223], v233, s[20:23], s43 offen offset:1024
    s_add_u32 s43, s47, 229376
    buffer_load_dwordx4 v[192:195], v233, s[32:35], s43 offen offset:0
    buffer_load_dwordx4 v[200:203], v233, s[32:35], s43 offen offset:1024
    s_add_u32 s43, s47, 491520
    buffer_load_dwordx4 v[196:199], v233, s[32:35], s43 offen offset:0
    buffer_load_dwordx4 v[204:207], v233, s[32:35], s43 offen offset:1024
    s_waitcnt vmcnt(16)
    v_mfma_f32_32x32x16_bf16 v[0:15], v[144:147], v[128:131], v[0:15]
    v_mfma_f32_32x32x16_bf16 v[16:31], v[144:147], v[132:135], v[16:31]
    v_mfma_f32_32x32x16_bf16 v[32:47], v[148:151], v[128:131], v[32:47]
    v_mfma_f32_32x32x16_bf16 v[48:63], v[148:151], v[132:135], v[48:63]
    v_mfma_f32_32x32x16_bf16 v[0:15], v[152:155], v[136:139], v[0:15]
    v_mfma_f32_32x32x16_bf16 v[16:31], v[152:155], v[140:143], v[16:31]
    v_mfma_f32_32x32x16_bf16 v[32:47], v[156:159], v[136:139], v[32:47]
    v_mfma_f32_32x32x16_bf16 v[48:63], v[156:159], v[140:143], v[48:63]
    s_add_u32 s43, s49, 245760
    buffer_load_dwordx4 v[144:147], v233, s[20:23], s43 offen offset:0
    buffer_load_dwordx4 v[152:155], v233, s[20:23], s43 offen offset:1024
    s_add_u32 s43, s49, 622592
    buffer_load_dwordx4 v[148:151], v233, s[20:23], s43 offen offset:0
    buffer_load_dwordx4 v[156:159], v233, s[20:23], s43 offen offset:1024
    s_add_u32 s43, s47, 245760
    buffer_load_dwordx4 v[128:131], v233, s[32:35], s43 offen offset:0
    buffer_load_dwordx4 v[136:139], v233, s[32:35], s43 offen offset:1024
    s_add_u32 s43, s47, 507904
    buffer_load_dwordx4 v[132:135], v233, s[32:35], s43 offen offset:0
    buffer_load_dwordx4 v[140:143], v233, s[32:35], s43 offen offset:1024
    s_waitcnt vmcnt(16)
    v_mfma_f32_32x32x16_bf16 v[0:15], v[176:179], v[160:163], v[0:15]
    v_mfma_f32_32x32x16_bf16 v[16:31], v[176:179], v[164:167], v[16:31]
    v_mfma_f32_32x32x16_bf16 v[32:47], v[180:183], v[160:163], v[32:47]
    v_mfma_f32_32x32x16_bf16 v[48:63], v[180:183], v[164:167], v[48:63]
    v_mfma_f32_32x32x16_bf16 v[0:15], v[184:187], v[168:171], v[0:15]
    v_mfma_f32_32x32x16_bf16 v[16:31], v[184:187], v[172:175], v[16:31]
    v_mfma_f32_32x32x16_bf16 v[32:47], v[188:191], v[168:171], v[32:47]
    v_mfma_f32_32x32x16_bf16 v[48:63], v[188:191], v[172:175], v[48:63]
    s_add_u32 s43, s49, 262144
    buffer_load_dwordx4 v[176:179], v233, s[20:23], s43 offen offset:0
    buffer_load_dwordx4 v[184:187], v233, s[20:23], s43 offen offset:1024
    s_add_u32 s43, s49, 638976
    buffer_load_dwordx4 v[180:183], v233, s[20:23], s43 offen offset:0
    buffer_load_dwordx4 v[188:191], v233, s[20:23], s43 offen offset:1024
    s_add_u32 s43, s48, 0
    buffer_load_dwordx4 v[160:163], v233, s[36:39], s43 offen offset:0
    buffer_load_dwordx4 v[168:171], v233, s[36:39], s43 offen offset:1024
    s_add_u32 s43, s48, 114688
    buffer_load_dwordx4 v[164:167], v233, s[36:39], s43 offen offset:0
    buffer_load_dwordx4 v[172:175], v233, s[36:39], s43 offen offset:1024
    s_waitcnt vmcnt(16)
    v_mfma_f32_32x32x16_bf16 v[0:15], v[208:211], v[192:195], v[0:15]
    v_mfma_f32_32x32x16_bf16 v[16:31], v[208:211], v[196:199], v[16:31]
    v_mfma_f32_32x32x16_bf16 v[32:47], v[212:215], v[192:195], v[32:47]
    v_mfma_f32_32x32x16_bf16 v[48:63], v[212:215], v[196:199], v[48:63]
    v_mfma_f32_32x32x16_bf16 v[0:15], v[216:219], v[200:203], v[0:15]
    v_mfma_f32_32x32x16_bf16 v[16:31], v[216:219], v[204:207], v[16:31]
    v_mfma_f32_32x32x16_bf16 v[32:47], v[220:223], v[200:203], v[32:47]
    v_mfma_f32_32x32x16_bf16 v[48:63], v[220:223], v[204:207], v[48:63]
    s_add_u32 s43, s49, 278528
    buffer_load_dwordx4 v[208:211], v233, s[20:23], s43 offen offset:0
    buffer_load_dwordx4 v[216:219], v233, s[20:23], s43 offen offset:1024
    s_add_u32 s43, s49, 655360
    buffer_load_dwordx4 v[212:215], v233, s[20:23], s43 offen offset:0
    buffer_load_dwordx4 v[220:223], v233, s[20:23], s43 offen offset:1024
    s_add_u32 s43, s48, 16384
    buffer_load_dwordx4 v[192:195], v233, s[36:39], s43 offen offset:0
    buffer_load_dwordx4 v[200:203], v233, s[36:39], s43 offen offset:1024
    s_add_u32 s43, s48, 131072
    buffer_load_dwordx4 v[196:199], v233, s[36:39], s43 offen offset:0
    buffer_load_dwordx4 v[204:207], v233, s[36:39], s43 offen offset:1024
    s_waitcnt vmcnt(16)
    v_mfma_f32_32x32x16_bf16 v[0:15], v[144:147], v[128:131], v[0:15]
    v_mfma_f32_32x32x16_bf16 v[16:31], v[144:147], v[132:135], v[16:31]
    v_mfma_f32_32x32x16_bf16 v[32:47], v[148:151], v[128:131], v[32:47]
    v_mfma_f32_32x32x16_bf16 v[48:63], v[148:151], v[132:135], v[48:63]
    v_mfma_f32_32x32x16_bf16 v[0:15], v[152:155], v[136:139], v[0:15]
    v_mfma_f32_32x32x16_bf16 v[16:31], v[152:155], v[140:143], v[16:31]
    v_mfma_f32_32x32x16_bf16 v[32:47], v[156:159], v[136:139], v[32:47]
    v_mfma_f32_32x32x16_bf16 v[48:63], v[156:159], v[140:143], v[48:63]
    s_add_u32 s43, s49, 294912
    buffer_load_dwordx4 v[144:147], v233, s[20:23], s43 offen offset:0
    buffer_load_dwordx4 v[152:155], v233, s[20:23], s43 offen offset:1024
    s_add_u32 s43, s49, 671744
    buffer_load_dwordx4 v[148:151], v233, s[20:23], s43 offen offset:0
    buffer_load_dwordx4 v[156:159], v233, s[20:23], s43 offen offset:1024
    s_add_u32 s43, s48, 32768
    buffer_load_dwordx4 v[128:131], v233, s[36:39], s43 offen offset:0
    buffer_load_dwordx4 v[136:139], v233, s[36:39], s43 offen offset:1024
    s_add_u32 s43, s48, 147456
    buffer_load_dwordx4 v[132:135], v233, s[36:39], s43 offen offset:0
    buffer_load_dwordx4 v[140:143], v233, s[36:39], s43 offen offset:1024
    s_waitcnt vmcnt(16)
    v_mfma_f32_32x32x16_bf16 v[64:79], v[176:179], v[160:163], 0
    v_mfma_f32_32x32x16_bf16 v[80:95], v[176:179], v[164:167], 0
    v_mfma_f32_32x32x16_bf16 v[96:111], v[180:183], v[160:163], 0
    v_mfma_f32_32x32x16_bf16 v[112:127], v[180:183], v[164:167], 0
    v_mfma_f32_32x32x16_bf16 v[64:79], v[184:187], v[168:171], v[64:79]
    v_mfma_f32_32x32x16_bf16 v[80:95], v[184:187], v[172:175], v[80:95]
    v_mfma_f32_32x32x16_bf16 v[96:111], v[188:191], v[168:171], v[96:111]
    v_mfma_f32_32x32x16_bf16 v[112:127], v[188:191], v[172:175], v[112:127]
    s_add_u32 s43, s49, 311296
    buffer_load_dwordx4 v[176:179], v233, s[20:23], s43 offen offset:0
    buffer_load_dwordx4 v[184:187], v233, s[20:23], s43 offen offset:1024
    s_add_u32 s43, s49, 688128
    buffer_load_dwordx4 v[180:183], v233, s[20:23], s43 offen offset:0
    buffer_load_dwordx4 v[188:191], v233, s[20:23], s43 offen offset:1024
    s_add_u32 s43, s48, 49152
    buffer_load_dwordx4 v[160:163], v233, s[36:39], s43 offen offset:0
    buffer_load_dwordx4 v[168:171], v233, s[36:39], s43 offen offset:1024
    s_add_u32 s43, s48, 163840
    buffer_load_dwordx4 v[164:167], v233, s[36:39], s43 offen offset:0
    buffer_load_dwordx4 v[172:175], v233, s[36:39], s43 offen offset:1024
    s_waitcnt vmcnt(16)
    v_mfma_f32_32x32x16_bf16 v[64:79], v[208:211], v[192:195], v[64:79]
    v_mfma_f32_32x32x16_bf16 v[80:95], v[208:211], v[196:199], v[80:95]
    v_mfma_f32_32x32x16_bf16 v[96:111], v[212:215], v[192:195], v[96:111]
    v_mfma_f32_32x32x16_bf16 v[112:127], v[212:215], v[196:199], v[112:127]
    v_mfma_f32_32x32x16_bf16 v[64:79], v[216:219], v[200:203], v[64:79]
    v_mfma_f32_32x32x16_bf16 v[80:95], v[216:219], v[204:207], v[80:95]
    v_mfma_f32_32x32x16_bf16 v[96:111], v[220:223], v[200:203], v[96:111]
    v_mfma_f32_32x32x16_bf16 v[112:127], v[220:223], v[204:207], v[112:127]
    s_add_u32 s43, s49, 327680
    buffer_load_dwordx4 v[208:211], v233, s[20:23], s43 offen offset:0
    buffer_load_dwordx4 v[216:219], v233, s[20:23], s43 offen offset:1024
    s_add_u32 s43, s49, 704512
    buffer_load_dwordx4 v[212:215], v233, s[20:23], s43 offen offset:0
    buffer_load_dwordx4 v[220:223], v233, s[20:23], s43 offen offset:1024
    s_add_u32 s43, s48, 65536
    buffer_load_dwordx4 v[192:195], v233, s[36:39], s43 offen offset:0
    buffer_load_dwordx4 v[200:203], v233, s[36:39], s43 offen offset:1024
    s_add_u32 s43, s48, 180224
    buffer_load_dwordx4 v[196:199], v233, s[36:39], s43 offen offset:0
    buffer_load_dwordx4 v[204:207], v233, s[36:39], s43 offen offset:1024
    s_waitcnt vmcnt(16)
    v_mfma_f32_32x32x16_bf16 v[64:79], v[144:147], v[128:131], v[64:79]
    v_mfma_f32_32x32x16_bf16 v[80:95], v[144:147], v[132:135], v[80:95]
    v_mfma_f32_32x32x16_bf16 v[96:111], v[148:151], v[128:131], v[96:111]
    v_mfma_f32_32x32x16_bf16 v[112:127], v[148:151], v[132:135], v[112:127]
    v_mfma_f32_32x32x16_bf16 v[64:79], v[152:155], v[136:139], v[64:79]
    v_mfma_f32_32x32x16_bf16 v[80:95], v[152:155], v[140:143], v[80:95]
    v_mfma_f32_32x32x16_bf16 v[96:111], v[156:159], v[136:139], v[96:111]
    v_mfma_f32_32x32x16_bf16 v[112:127], v[156:159], v[140:143], v[112:127]
    s_add_u32 s43, s49, 344064
    buffer_load_dwordx4 v[144:147], v233, s[20:23], s43 offen offset:0
    buffer_load_dwordx4 v[152:155], v233, s[20:23], s43 offen offset:1024
    s_add_u32 s43, s49, 720896
    buffer_load_dwordx4 v[148:151], v233, s[20:23], s43 offen offset:0
    buffer_load_dwordx4 v[156:159], v233, s[20:23], s43 offen offset:1024
    s_add_u32 s43, s48, 81920
    buffer_load_dwordx4 v[128:131], v233, s[36:39], s43 offen offset:0
    buffer_load_dwordx4 v[136:139], v233, s[36:39], s43 offen offset:1024
    s_add_u32 s43, s48, 196608
    buffer_load_dwordx4 v[132:135], v233, s[36:39], s43 offen offset:0
    buffer_load_dwordx4 v[140:143], v233, s[36:39], s43 offen offset:1024
    s_waitcnt vmcnt(16)
    v_mfma_f32_32x32x16_bf16 v[64:79], v[176:179], v[160:163], v[64:79]
    v_mfma_f32_32x32x16_bf16 v[80:95], v[176:179], v[164:167], v[80:95]
    v_mfma_f32_32x32x16_bf16 v[96:111], v[180:183], v[160:163], v[96:111]
    v_mfma_f32_32x32x16_bf16 v[112:127], v[180:183], v[164:167], v[112:127]
    v_mfma_f32_32x32x16_bf16 v[64:79], v[184:187], v[168:171], v[64:79]
    v_mfma_f32_32x32x16_bf16 v[80:95], v[184:187], v[172:175], v[80:95]
    v_mfma_f32_32x32x16_bf16 v[96:111], v[188:191], v[168:171], v[96:111]
    v_mfma_f32_32x32x16_bf16 v[112:127], v[188:191], v[172:175], v[112:127]
    s_add_u32 s43, s49, 360448
    buffer_load_dwordx4 v[176:179], v233, s[20:23], s43 offen offset:0
    buffer_load_dwordx4 v[184:187], v233, s[20:23], s43 offen offset:1024
    s_add_u32 s43, s49, 737280
    buffer_load_dwordx4 v[180:183], v233, s[20:23], s43 offen offset:0
    buffer_load_dwordx4 v[188:191], v233, s[20:23], s43 offen offset:1024
    s_add_u32 s43, s48, 98304
    buffer_load_dwordx4 v[160:163], v233, s[36:39], s43 offen offset:0
    buffer_load_dwordx4 v[168:171], v233, s[36:39], s43 offen offset:1024
    s_add_u32 s43, s48, 212992
    buffer_load_dwordx4 v[164:167], v233, s[36:39], s43 offen offset:0
    buffer_load_dwordx4 v[172:175], v233, s[36:39], s43 offen offset:1024
    s_waitcnt vmcnt(16)
    v_mfma_f32_32x32x16_bf16 v[64:79], v[208:211], v[192:195], v[64:79]
    v_mfma_f32_32x32x16_bf16 v[80:95], v[208:211], v[196:199], v[80:95]
    v_mfma_f32_32x32x16_bf16 v[96:111], v[212:215], v[192:195], v[96:111]
    v_mfma_f32_32x32x16_bf16 v[112:127], v[212:215], v[196:199], v[112:127]
    v_mfma_f32_32x32x16_bf16 v[64:79], v[216:219], v[200:203], v[64:79]
    v_mfma_f32_32x32x16_bf16 v[80:95], v[216:219], v[204:207], v[80:95]
    v_mfma_f32_32x32x16_bf16 v[96:111], v[220:223], v[200:203], v[96:111]
    v_mfma_f32_32x32x16_bf16 v[112:127], v[220:223], v[204:207], v[112:127]
    s_waitcnt vmcnt(8)
    v_mfma_f32_32x32x16_bf16 v[64:79], v[144:147], v[128:131], v[64:79]
    v_mfma_f32_32x32x16_bf16 v[80:95], v[144:147], v[132:135], v[80:95]
    v_mfma_f32_32x32x16_bf16 v[96:111], v[148:151], v[128:131], v[96:111]
    v_mfma_f32_32x32x16_bf16 v[112:127], v[148:151], v[132:135], v[112:127]
    v_mfma_f32_32x32x16_bf16 v[64:79], v[152:155], v[136:139], v[64:79]
    v_mfma_f32_32x32x16_bf16 v[80:95], v[152:155], v[140:143], v[80:95]
    v_mfma_f32_32x32x16_bf16 v[96:111], v[156:159], v[136:139], v[96:111]
    v_mfma_f32_32x32x16_bf16 v[112:127], v[156:159], v[140:143], v[112:127]
    s_waitcnt vmcnt(0)
    v_mfma_f32_32x32x16_bf16 v[64:79], v[176:179], v[160:163], v[64:79]
    v_mfma_f32_32x32x16_bf16 v[80:95], v[176:179], v[164:167], v[80:95]
    v_mfma_f32_32x32x16_bf16 v[96:111], v[180:183], v[160:163], v[96:111]
    v_mfma_f32_32x32x16_bf16 v[112:127], v[180:183], v[164:167], v[112:127]
    v_mfma_f32_32x32x16_bf16 v[64:79], v[184:187], v[168:171], v[64:79]
    v_mfma_f32_32x32x16_bf16 v[80:95], v[184:187], v[172:175], v[80:95]
    v_mfma_f32_32x32x16_bf16 v[96:111], v[188:191], v[168:171], v[96:111]
    v_mfma_f32_32x32x16_bf16 v[112:127], v[188:191], v[172:175], v[112:127]
    s_nop 15
    s_nop 3
    s_bfe_u32 s43, s42, 0x10001
    s_lshl_b32 s43, s43, 5
    s_lshl_b32 s44, s40, 6
    s_add_u32 s43, s43, s44
    v_and_b32 v225, 31, v224
    v_add_u32 v225, s43, v225
    v_lshrrev_b32 v226, 5, v224
    v_lshlrev_b32 v226, 4, v226
    v_lshl_add_u32 v234, v225, 10, v226
    s_lshr_b32 s43, s42, 2
    s_lshl_b32 s43, s43, 6
    s_and_b32 s44, s42, 1
    s_lshl_b32 s44, s44, 5
    s_add_u32 s43, s43, s44
    s_lshl_b32 s44, s41, 7
    s_add_u32 s43, s43, s44
    v_add_u32 v234, s43, v234
    buffer_load_dwordx4 v[236:239], v234, s[16:19], 0 offen
    s_lshl_b32 s43, s42, 14
    v_add_u32 v225, s43, v233
    s_lshl_b32 s43, s42, 11
    v_add_u32 v235, s43, v233
    v_add_u32 v229, 0x10000, v235
    s_barrier
    ds_write_b128 v225, v[0:3] offset:0
    ds_write_b128 v225, v[4:7] offset:1024
    ds_write_b128 v225, v[8:11] offset:2048
    ds_write_b128 v225, v[12:15] offset:3072
    ds_write_b128 v225, v[16:19] offset:4096
    ds_write_b128 v225, v[20:23] offset:5120
    ds_write_b128 v225, v[24:27] offset:6144
    ds_write_b128 v225, v[28:31] offset:7168
    ds_write_b128 v225, v[32:35] offset:8192
    ds_write_b128 v225, v[36:39] offset:9216
    ds_write_b128 v225, v[40:43] offset:10240
    ds_write_b128 v225, v[44:47] offset:11264
    ds_write_b128 v225, v[48:51] offset:12288
    ds_write_b128 v225, v[52:55] offset:13312
    ds_write_b128 v225, v[56:59] offset:14336
    ds_write_b128 v225, v[60:63] offset:15360
    s_waitcnt lgkmcnt(0)
    s_barrier
    ds_read_b128 v[0:3], v235 offset:0
    ds_read_b128 v[4:7], v235 offset:1024
    ds_read_b128 v[8:11], v235 offset:16384
    ds_read_b128 v[12:15], v235 offset:17408
    ds_read_b128 v[16:19], v235 offset:32768
    ds_read_b128 v[20:23], v235 offset:33792
    ds_read_b128 v[24:27], v235 offset:49152
    ds_read_b128 v[28:31], v235 offset:50176
    ds_read_b128 v[32:35], v229 offset:0
    ds_read_b128 v[36:39], v229 offset:1024
    ds_read_b128 v[40:43], v229 offset:16384
    ds_read_b128 v[44:47], v229 offset:17408
    ds_read_b128 v[48:51], v229 offset:32768
    ds_read_b128 v[52:55], v229 offset:33792
    s_waitcnt lgkmcnt(0)
    ds_read_b128 v[56:59], v229 offset:49152
    ds_read_b128 v[60:63], v229 offset:50176
    s_waitcnt lgkmcnt(0)
    v_add_f32 v0, v0, v8
    v_add_f32 v16, v16, v24
    v_add_f32 v32, v32, v40
    v_add_f32 v48, v48, v56
    v_add_f32 v1, v1, v9
    v_add_f32 v17, v17, v25
    v_add_f32 v33, v33, v41
    v_add_f32 v49, v49, v57
    v_add_f32 v2, v2, v10
    v_add_f32 v18, v18, v26
    v_add_f32 v34, v34, v42
    v_add_f32 v50, v50, v58
    v_add_f32 v3, v3, v11
    v_add_f32 v19, v19, v27
    v_add_f32 v35, v35, v43
    v_add_f32 v51, v51, v59
    v_add_f32 v4, v4, v12
    v_add_f32 v20, v20, v28
    v_add_f32 v36, v36, v44
    v_add_f32 v52, v52, v60
    v_add_f32 v5, v5, v13
    v_add_f32 v21, v21, v29
    v_add_f32 v37, v37, v45
    v_add_f32 v53, v53, v61
    v_add_f32 v6, v6, v14
    v_add_f32 v22, v22, v30
    v_add_f32 v38, v38, v46
    v_add_f32 v54, v54, v62
    v_add_f32 v7, v7, v15
    v_add_f32 v23, v23, v31
    v_add_f32 v39, v39, v47
    v_add_f32 v55, v55, v63
    v_add_f32 v0, v0, v16
    v_add_f32 v32, v32, v48
    v_add_f32 v1, v1, v17
    v_add_f32 v33, v33, v49
    v_add_f32 v2, v2, v18
    v_add_f32 v34, v34, v50
    v_add_f32 v3, v3, v19
    v_add_f32 v35, v35, v51
    v_add_f32 v4, v4, v20
    v_add_f32 v36, v36, v52
    v_add_f32 v5, v5, v21
    v_add_f32 v37, v37, v53
    v_add_f32 v6, v6, v22
    v_add_f32 v38, v38, v54
    v_add_f32 v7, v7, v23
    v_add_f32 v39, v39, v55
    v_add_f32 v0, v0, v32
    v_add_f32 v1, v1, v33
    v_add_f32 v2, v2, v34
    v_add_f32 v3, v3, v35
    v_add_f32 v4, v4, v36
    v_add_f32 v5, v5, v37
    v_add_f32 v6, v6, v38
    v_add_f32 v7, v7, v39
    s_barrier
    ds_write_b128 v225, v[64:67] offset:0
    ds_write_b128 v225, v[68:71] offset:1024
    ds_write_b128 v225, v[72:75] offset:2048
    ds_write_b128 v225, v[76:79] offset:3072
    ds_write_b128 v225, v[80:83] offset:4096
    ds_write_b128 v225, v[84:87] offset:5120
    ds_write_b128 v225, v[88:91] offset:6144
    ds_write_b128 v225, v[92:95] offset:7168
    ds_write_b128 v225, v[96:99] offset:8192
    ds_write_b128 v225, v[100:103] offset:9216
    ds_write_b128 v225, v[104:107] offset:10240
    ds_write_b128 v225, v[108:111] offset:11264
    ds_write_b128 v225, v[112:115] offset:12288
    ds_write_b128 v225, v[116:119] offset:13312
    ds_write_b128 v225, v[120:123] offset:14336
    ds_write_b128 v225, v[124:127] offset:15360
    s_waitcnt lgkmcnt(0)
    s_barrier
    ds_read_b128 v[64:67], v235 offset:0
    ds_read_b128 v[68:71], v235 offset:1024
    ds_read_b128 v[72:75], v235 offset:16384
    ds_read_b128 v[76:79], v235 offset:17408
    ds_read_b128 v[80:83], v235 offset:32768
    ds_read_b128 v[84:87], v235 offset:33792
    ds_read_b128 v[88:91], v235 offset:49152
    ds_read_b128 v[92:95], v235 offset:50176
    ds_read_b128 v[96:99], v229 offset:0
    ds_read_b128 v[100:103], v229 offset:1024
    ds_read_b128 v[104:107], v229 offset:16384
    ds_read_b128 v[108:111], v229 offset:17408
    ds_read_b128 v[112:115], v229 offset:32768
    ds_read_b128 v[116:119], v229 offset:33792
    s_waitcnt lgkmcnt(0)
    ds_read_b128 v[120:123], v229 offset:49152
    ds_read_b128 v[124:127], v229 offset:50176
    s_waitcnt lgkmcnt(0)
    v_add_f32 v64, v64, v72
    v_add_f32 v80, v80, v88
    v_add_f32 v96, v96, v104
    v_add_f32 v112, v112, v120
    v_add_f32 v65, v65, v73
    v_add_f32 v81, v81, v89
    v_add_f32 v97, v97, v105
    v_add_f32 v113, v113, v121
    v_add_f32 v66, v66, v74
    v_add_f32 v82, v82, v90
    v_add_f32 v98, v98, v106
    v_add_f32 v114, v114, v122
    v_add_f32 v67, v67, v75
    v_add_f32 v83, v83, v91
    v_add_f32 v99, v99, v107
    v_add_f32 v115, v115, v123
    v_add_f32 v68, v68, v76
    v_add_f32 v84, v84, v92
    v_add_f32 v100, v100, v108
    v_add_f32 v116, v116, v124
    v_add_f32 v69, v69, v77
    v_add_f32 v85, v85, v93
    v_add_f32 v101, v101, v109
    v_add_f32 v117, v117, v125
    v_add_f32 v70, v70, v78
    v_add_f32 v86, v86, v94
    v_add_f32 v102, v102, v110
    v_add_f32 v118, v118, v126
    v_add_f32 v71, v71, v79
    v_add_f32 v87, v87, v95
    v_add_f32 v103, v103, v111
    v_add_f32 v119, v119, v127
    v_add_f32 v64, v64, v80
    v_add_f32 v96, v96, v112
    v_add_f32 v65, v65, v81
    v_add_f32 v97, v97, v113
    v_add_f32 v66, v66, v82
    v_add_f32 v98, v98, v114
    v_add_f32 v67, v67, v83
    v_add_f32 v99, v99, v115
    v_add_f32 v68, v68, v84
    v_add_f32 v100, v100, v116
    v_add_f32 v69, v69, v85
    v_add_f32 v101, v101, v117
    v_add_f32 v70, v70, v86
    v_add_f32 v102, v102, v118
    v_add_f32 v71, v71, v87
    v_add_f32 v103, v103, v119
    v_add_f32 v64, v64, v96
    v_add_f32 v65, v65, v97
    v_add_f32 v66, v66, v98
    v_add_f32 v67, v67, v99
    v_add_f32 v68, v68, v100
    v_add_f32 v69, v69, v101
    v_add_f32 v70, v70, v102
    v_add_f32 v71, v71, v103
    s_waitcnt vmcnt(0)
    s_mov_b32 s45, 0xbfb8aa3b
    v_cvt_pk_bf16_f32 v225, v0, v1
    v_lshlrev_b32 v0, 16, v225
    v_and_b32 v1, 0xffff0000, v225
    v_cvt_pk_bf16_f32 v225, v64, v65
    v_lshlrev_b32 v64, 16, v225
    v_and_b32 v65, 0xffff0000, v225
    v_mul_f32 v225, s45, v64
    v_mul_f32 v226, s45, v65
    v_exp_f32 v225, v225
    v_exp_f32 v226, v226
    s_nop 0
    v_add_f32 v225, 1.0, v225
    v_add_f32 v226, 1.0, v226
    v_rcp_f32 v225, v225
    v_rcp_f32 v226, v226
    s_nop 0
    v_mul_f32 v64, v64, v225
    v_mul_f32 v65, v65, v226
    v_cvt_pk_bf16_f32 v225, v64, v65
    v_lshlrev_b32 v64, 16, v225
    v_and_b32 v65, 0xffff0000, v225
    v_mul_f32 v0, v0, v64
    v_mul_f32 v1, v1, v65
    v_cvt_pk_bf16_f32 v225, v0, v1
    v_lshlrev_b32 v0, 16, v225
    v_and_b32 v1, 0xffff0000, v225
    v_lshlrev_b32 v225, 16, v236
    v_and_b32 v226, 0xffff0000, v236
    v_add_f32 v0, v0, v225
    v_add_f32 v1, v1, v226
    v_cvt_pk_bf16_f32 v236, v0, v1
    v_cvt_pk_bf16_f32 v225, v2, v3
    v_lshlrev_b32 v2, 16, v225
    v_and_b32 v3, 0xffff0000, v225
    v_cvt_pk_bf16_f32 v225, v66, v67
    v_lshlrev_b32 v66, 16, v225
    v_and_b32 v67, 0xffff0000, v225
    v_mul_f32 v225, s45, v66
    v_mul_f32 v226, s45, v67
    v_exp_f32 v225, v225
    v_exp_f32 v226, v226
    s_nop 0
    v_add_f32 v225, 1.0, v225
    v_add_f32 v226, 1.0, v226
    v_rcp_f32 v225, v225
    v_rcp_f32 v226, v226
    s_nop 0
    v_mul_f32 v66, v66, v225
    v_mul_f32 v67, v67, v226
    v_cvt_pk_bf16_f32 v225, v66, v67
    v_lshlrev_b32 v66, 16, v225
    v_and_b32 v67, 0xffff0000, v225
    v_mul_f32 v2, v2, v66
    v_mul_f32 v3, v3, v67
    v_cvt_pk_bf16_f32 v225, v2, v3
    v_lshlrev_b32 v2, 16, v225
    v_and_b32 v3, 0xffff0000, v225
    v_lshlrev_b32 v225, 16, v237
    v_and_b32 v226, 0xffff0000, v237
    v_add_f32 v2, v2, v225
    v_add_f32 v3, v3, v226
    v_cvt_pk_bf16_f32 v237, v2, v3
    v_cvt_pk_bf16_f32 v225, v4, v5
    v_lshlrev_b32 v4, 16, v225
    v_and_b32 v5, 0xffff0000, v225
    v_cvt_pk_bf16_f32 v225, v68, v69
    v_lshlrev_b32 v68, 16, v225
    v_and_b32 v69, 0xffff0000, v225
    v_mul_f32 v225, s45, v68
    v_mul_f32 v226, s45, v69
    v_exp_f32 v225, v225
    v_exp_f32 v226, v226
    s_nop 0
    v_add_f32 v225, 1.0, v225
    v_add_f32 v226, 1.0, v226
    v_rcp_f32 v225, v225
    v_rcp_f32 v226, v226
    s_nop 0
    v_mul_f32 v68, v68, v225
    v_mul_f32 v69, v69, v226
    v_cvt_pk_bf16_f32 v225, v68, v69
    v_lshlrev_b32 v68, 16, v225
    v_and_b32 v69, 0xffff0000, v225
    v_mul_f32 v4, v4, v68
    v_mul_f32 v5, v5, v69
    v_cvt_pk_bf16_f32 v225, v4, v5
    v_lshlrev_b32 v4, 16, v225
    v_and_b32 v5, 0xffff0000, v225
    v_lshlrev_b32 v225, 16, v238
    v_and_b32 v226, 0xffff0000, v238
    v_add_f32 v4, v4, v225
    v_add_f32 v5, v5, v226
    v_cvt_pk_bf16_f32 v238, v4, v5
    v_cvt_pk_bf16_f32 v225, v6, v7
    v_lshlrev_b32 v6, 16, v225
    v_and_b32 v7, 0xffff0000, v225
    v_cvt_pk_bf16_f32 v225, v70, v71
    v_lshlrev_b32 v70, 16, v225
    v_and_b32 v71, 0xffff0000, v225
    v_mul_f32 v225, s45, v70
    v_mul_f32 v226, s45, v71
    v_exp_f32 v225, v225
    v_exp_f32 v226, v226
    s_nop 0
    v_add_f32 v225, 1.0, v225
    v_add_f32 v226, 1.0, v226
    v_rcp_f32 v225, v225
    v_rcp_f32 v226, v226
    s_nop 0
    v_mul_f32 v70, v70, v225
    v_mul_f32 v71, v71, v226
    v_cvt_pk_bf16_f32 v225, v70, v71
    v_lshlrev_b32 v70, 16, v225
    v_and_b32 v71, 0xffff0000, v225
    v_mul_f32 v6, v6, v70
    v_mul_f32 v7, v7, v71
    v_cvt_pk_bf16_f32 v225, v6, v7
    v_lshlrev_b32 v6, 16, v225
    v_and_b32 v7, 0xffff0000, v225
    v_lshlrev_b32 v225, 16, v239
    v_and_b32 v226, 0xffff0000, v239
    v_add_f32 v6, v6, v225
    v_add_f32 v7, v7, v226
    v_cvt_pk_bf16_f32 v239, v6, v7
    buffer_store_dwordx4 v[236:239], v234, s[28:31], 0 offen
L_outp_end:
    s_endpgm
.section .rodata,"a"
.p2align 6
.amdhsa_kernel lnorm_kernel
  .amdhsa_next_free_vgpr 32
  .amdhsa_next_free_sgpr 102
  .amdhsa_accum_offset 32
  .amdhsa_group_segment_fixed_size 0
  .amdhsa_kernarg_size 96
  .amdhsa_user_sgpr_count 2
  .amdhsa_user_sgpr_kernarg_segment_ptr 1
  .amdhsa_system_sgpr_workgroup_id_x 1
.end_amdhsa_kernel
.p2align 6
.amdhsa_kernel attn_kernel
  .amdhsa_next_free_vgpr 256
  .amdhsa_next_free_sgpr 102
  .amdhsa_accum_offset 256
  .amdhsa_group_segment_fixed_size 0
  .amdhsa_kernarg_size 96
  .amdhsa_user_sgpr_count 2
  .amdhsa_user_sgpr_kernarg_segment_ptr 1
  .amdhsa_system_sgpr_workgroup_id_x 1
.end_amdhsa_kernel
.p2align 6
.amdhsa_kernel outp_kernel
  .amdhsa_next_free_vgpr 240
  .amdhsa_next_free_sgpr 102
  .amdhsa_accum_offset 240
  .amdhsa_group_segment_fixed_size 0
  .amdhsa_kernarg_size 96
  .amdhsa_user_sgpr_count 2
  .amdhsa_user_sgpr_kernarg_segment_ptr 1
  .amdhsa_system_sgpr_workgroup_id_x 1
.end_amdhsa_kernel
```
